```python
import torch

def _softmax(x, axis=-1):
    return torch.softmax(x, dim=axis)

def _gelu(x):
    return torch.nn.functional.gelu(x, approximate='tanh')

def _silu(x):
    return torch.nn.functional.silu(x)

def _sigmoid(x):
    return torch.sigmoid(x)

def _layernorm(x, axis=-1, eps=1e-05):
    m = x.mean(dim=axis, keepdim=True)
    v = x.var(dim=axis, keepdim=True, unbiased=False)
    return (x - m) / torch.sqrt(v + eps)

def _scatter_add(tgt, idx, src, axis=0):
    return tgt.clone().index_add_(axis, idx, src)

def _segment_sum(src, seg, n):
    out = torch.zeros((n,) + src.shape[1:], dtype=src.dtype)
    return out.index_add_(0, seg, src)

def _pad(x, pw):
    flat = tuple((v for pair in reversed(pw) for v in pair))
    return torch.nn.functional.pad(x, flat)
kernel_name = 'standalone__dit_adaln_block__diffusion'

def setup_inputs():

    _w = lambda a: (lambda t: t.to(torch.bfloat16) if t.is_floating_point() else t)(torch.as_tensor(a))
    B, N, D = (2, 1024, 384)
    return {'x': _w((lambda *s: torch.randn(*s, dtype=torch.bfloat16) * 0.05)(B, N, D)), 'c': _w((lambda *s: torch.randn(*s, dtype=torch.bfloat16) * 0.2)(B, D)), 'wqkv': _w((lambda *s: torch.randn(*s, dtype=torch.bfloat16) * 0.05)(D, 3 * D)), 'wo': _w((lambda *s: torch.randn(*s, dtype=torch.bfloat16) * 0.1)(D, D)), 'w_mod': _w((lambda *s: torch.randn(*s, dtype=torch.bfloat16) * 0.2)(D, 6 * D))}

def reference(x, c, wqkv, wo, w_mod):
    B, N, D = x.shape
    mod = (_silu(c) @ w_mod).reshape(B, 6, 1, D)
    shift_a, scale_a, gate_a, shift_m, scale_m, gate_m = [mod[:, i] for i in range(6)]
    h = _layernorm(x, axis=-1) * (1 + scale_a) + shift_a
    qkv = h @ wqkv
    q, k, v = (qkv[..., :D].clone(), qkv[..., D:2 * D].clone(), qkv[..., 2 * D:].clone())
    p = _softmax(torch.einsum('bqd,bkd->bqk', q, k) * D ** (-0.5), axis=-1)
    a = torch.einsum('bqk,bkd->bqd', p, v) @ wo
    return x + gate_a * a
```

```asm
; @launch kernel=prep_kernel grid=(296,1,1) block=(256,1,1) lds=73728
; @launch kernel=main_kernel grid=(256,1,1) block=(256,1,1) lds=149504
.amdgcn_target "amdgcn-amd-amdhsa--gfx950"
.text
.globl prep_kernel
.p2align 8
.type prep_kernel,@function
prep_kernel:
    s_cmp_ge_u32 s2, 296
    s_cbranch_scc1 LN_p_exit
    s_load_dwordx16 s[4:19], s[0:1], 0
    v_and_b32 v1, 63, v0
    v_lshrrev_b32 v2, 6, v0
    s_and_b32 s79, s2, 7
    v_readfirstlane_b32 s3, v2
    v_lshlrev_b32 v2, 4, v1
    v_and_b32 v6, 15, v1
    v_lshrrev_b32 v7, 4, v1
    s_cmp_lt_u32 s2, 128
    s_cbranch_scc1 LN_p_ln
    s_cmp_lt_u32 s2, 146
    s_cbranch_scc1 LN_p_dec_mod
    s_cmp_lt_u32 s2, 152
    s_cbranch_scc1 LN_p_exit
    s_sub_u32 s78, s2, 152
    s_lshr_b32 s78, s78, 3
    s_lshr_b32 s33, s79, 2
    s_mul_i32 s30, s78, 43691
    s_lshr_b32 s30, s30, 17
    s_bfe_u32 s34, s79, 0x10001
    s_mul_i32 s34, s34, 6
    s_add_u32 s34, s34, s30
    s_mul_i32 s30, s30, 3
    s_sub_u32 s30, s78, s30
    s_and_b32 s35, s79, 1
    s_mul_i32 s35, s35, 3
    s_add_u32 s35, s35, s30
    s_branch LN_p_dec
LN_p_dec_mod:
    s_mov_b32 s33, 2
    s_mov_b32 s34, 0
    s_sub_u32 s35, s2, 128
LN_p_dec:
    s_lshl_b32 s30, s3, 6
    s_add_u32 s30, s30, 0
    v_add_u32 v9, s30, v1
    v_mul_u32_u24 v10, 43691, v9
    v_lshrrev_b32 v10, 21, v10
    v_mul_u32_u24 v11, 48, v10
    v_sub_u32 v9, v9, v11
    v_xor_b32 v9, v9, v10
    v_mul_u32_u24 v10, 2304, v10
    v_lshl_add_u32 v16, v9, 4, v10
    s_lshl_b32 s30, s3, 6
    s_add_u32 s30, s30, 256
    v_add_u32 v9, s30, v1
    v_mul_u32_u24 v10, 43691, v9
    v_lshrrev_b32 v10, 21, v10
    v_mul_u32_u24 v11, 48, v10
    v_sub_u32 v9, v9, v11
    v_xor_b32 v9, v9, v10
    v_mul_u32_u24 v10, 2304, v10
    v_lshl_add_u32 v17, v9, 4, v10
    s_lshl_b32 s30, s3, 6
    s_add_u32 s30, s30, 512
    v_add_u32 v9, s30, v1
    v_mul_u32_u24 v10, 43691, v9
    v_lshrrev_b32 v10, 21, v10
    v_mul_u32_u24 v11, 48, v10
    v_sub_u32 v9, v9, v11
    v_xor_b32 v9, v9, v10
    v_mul_u32_u24 v10, 2304, v10
    v_lshl_add_u32 v18, v9, 4, v10
    v_lshrrev_b32 v9, 3, v1
    v_bfe_u32 v10, v9, 1, 1
    s_and_b32 s30, s3, 1
    s_lshl_b32 s30, s30, 1
    v_or_b32 v10, s30, v10
    v_lshlrev_b32 v10, 1, v10
    v_and_b32 v11, 7, v1
    v_xor_b32 v11, v11, v10
    v_lshlrev_b32 v11, 4, v11
    s_mov_b32 s36, 768
    s_cmp_eq_u32 s33, 2
    s_cselect_b32 s36, 4608, s36
    v_mul_lo_u32 v9, v9, s36
    v_add_u32 v19, v9, v11
    v_mul_u32_u24 v9, 768, v6
    v_xor_b32 v10, v7, v6
    v_xor_b32 v11, 0, v10
    v_lshl_add_u32 v20, v11, 4, v9
    v_xor_b32 v11, 4, v10
    v_lshl_add_u32 v21, v11, 4, v9
    v_xor_b32 v11, 8, v10
    v_lshl_add_u32 v22, v11, 4, v9
    v_xor_b32 v11, 12, v10
    v_lshl_add_u32 v23, v11, 4, v9
    s_mul_i32 s30, s3, 12288
    s_add_u32 s37, s30, 24576
    v_lshrrev_b32 v9, 2, v6
    v_lshl_add_u32 v10, v7, 3, v9
    v_lshlrev_b32 v10, 7, v10
    v_bfe_u32 v11, v9, 1, 1
    v_and_b32 v12, 1, v7
    v_lshl_or_b32 v11, v12, 1, v11
    v_xor_b32 v11, s3, v11
    v_lshl_add_u32 v10, v11, 5, v10
    v_and_b32 v11, 3, v6
    v_lshl_add_u32 v24, v11, 3, v10
    v_add_u32 v24, 24576, v24
    s_lshl_b32 s38, s3, 10
    s_waitcnt lgkmcnt(0)
    s_mov_b32 s56, s8
    s_and_b32 s57, s9, 0xffff
    s_mov_b32 s58, 884736
    s_mov_b32 s59, 0x00020000
    s_mov_b32 s20, s18
    s_and_b32 s21, s19, 0xffff
    s_mov_b32 s22, 29360128
    s_mov_b32 s23, 0x00020000
    s_cmp_eq_u32 s33, 2
    s_cbranch_scc1 LN_p_mod
    s_mul_i32 s30, s34, 73728
    s_mul_i32 s31, s33, 1536
    s_add_u32 s30, s30, s31
    s_add_u32 m0, s38, 0
    s_nop 0
    buffer_load_dwordx4 v16, s[56:59], s30 offen lds
    s_add_u32 m0, s38, 4096
    s_nop 0
    buffer_load_dwordx4 v17, s[56:59], s30 offen lds
    s_add_u32 m0, s38, 8192
    s_nop 0
    buffer_load_dwordx4 v18, s[56:59], s30 offen lds
    s_add_u32 s30, s30, 36864
    s_add_u32 m0, s38, 12288
    s_nop 0
    buffer_load_dwordx4 v16, s[56:59], s30 offen lds
    s_add_u32 m0, s38, 16384
    s_nop 0
    buffer_load_dwordx4 v17, s[56:59], s30 offen lds
    s_add_u32 m0, s38, 20480
    s_nop 0
    buffer_load_dwordx4 v18, s[56:59], s30 offen lds
    s_add_u32 s30, s30, 36864
    s_cmp_eq_u32 s33, 1
    s_cbranch_scc1 LN_p_vo
    s_mul_i32 s30, s35, 147456
    s_add_u32 s30, s30, 768
    s_add_u32 m0, s38, 24576
    s_nop 0
    buffer_load_dwordx4 v16, s[56:59], s30 offen lds
    s_add_u32 m0, s38, 28672
    s_nop 0
    buffer_load_dwordx4 v17, s[56:59], s30 offen lds
    s_add_u32 m0, s38, 32768
    s_nop 0
    buffer_load_dwordx4 v18, s[56:59], s30 offen lds
    s_add_u32 s30, s30, 36864
    s_add_u32 m0, s38, 36864
    s_nop 0
    buffer_load_dwordx4 v16, s[56:59], s30 offen lds
    s_add_u32 m0, s38, 40960
    s_nop 0
    buffer_load_dwordx4 v17, s[56:59], s30 offen lds
    s_add_u32 m0, s38, 45056
    s_nop 0
    buffer_load_dwordx4 v18, s[56:59], s30 offen lds
    s_add_u32 s30, s30, 36864
    s_add_u32 m0, s38, 49152
    s_nop 0
    buffer_load_dwordx4 v16, s[56:59], s30 offen lds
    s_add_u32 m0, s38, 53248
    s_nop 0
    buffer_load_dwordx4 v17, s[56:59], s30 offen lds
    s_add_u32 m0, s38, 57344
    s_nop 0
    buffer_load_dwordx4 v18, s[56:59], s30 offen lds
    s_add_u32 s30, s30, 36864
    s_add_u32 m0, s38, 61440
    s_nop 0
    buffer_load_dwordx4 v16, s[56:59], s30 offen lds
    s_add_u32 m0, s38, 65536
    s_nop 0
    buffer_load_dwordx4 v17, s[56:59], s30 offen lds
    s_add_u32 m0, s38, 69632
    s_nop 0
    buffer_load_dwordx4 v18, s[56:59], s30 offen lds
    s_add_u32 s30, s30, 36864
    s_branch LN_p_wait
LN_p_mod:
    s_mov_b32 s64, s6
    s_and_b32 s65, s7, 0xffff
    s_mov_b32 s66, 1536
    s_mov_b32 s67, 0x00020000
    v_lshlrev_b32 v9, 3, v0
    buffer_load_dwordx2 v[12:13], v9, s[64:67], 0 offen
    s_mov_b32 s60, s12
    s_and_b32 s61, s13, 0xffff
    s_mov_b32 s62, 1769472
    s_mov_b32 s63, 0x00020000
    s_branch LN_p_cols
LN_p_vo:
    s_mov_b32 s60, s10
    s_and_b32 s61, s11, 0xffff
    s_mov_b32 s62, 294912
    s_mov_b32 s63, 0x00020000
LN_p_cols:
    s_lshl_b32 s30, s36, 3
    s_mul_i32 s30, s30, s3
    s_lshl_b32 s31, s35, 7
    s_add_u32 s30, s30, s31
    s_lshl_b32 s31, s36, 5
    s_add_u32 m0, s38, 24576
    s_nop 0
    buffer_load_dwordx4 v19, s[60:63], s30 offen lds
    s_add_u32 s30, s30, s31
    s_add_u32 m0, s38, 28672
    s_nop 0
    buffer_load_dwordx4 v19, s[60:63], s30 offen lds
    s_add_u32 s30, s30, s31
    s_add_u32 m0, s38, 32768
    s_nop 0
    buffer_load_dwordx4 v19, s[60:63], s30 offen lds
    s_add_u32 s30, s30, s31
    s_add_u32 m0, s38, 36864
    s_nop 0
    buffer_load_dwordx4 v19, s[60:63], s30 offen lds
    s_add_u32 s30, s30, s31
    s_add_u32 m0, s38, 40960
    s_nop 0
    buffer_load_dwordx4 v19, s[60:63], s30 offen lds
    s_add_u32 s30, s30, s31
    s_add_u32 m0, s38, 45056
    s_nop 0
    buffer_load_dwordx4 v19, s[60:63], s30 offen lds
    s_add_u32 s30, s30, s31
    s_add_u32 m0, s38, 49152
    s_nop 0
    buffer_load_dwordx4 v19, s[60:63], s30 offen lds
    s_add_u32 s30, s30, s31
    s_add_u32 m0, s38, 53248
    s_nop 0
    buffer_load_dwordx4 v19, s[60:63], s30 offen lds
    s_add_u32 s30, s30, s31
    s_add_u32 m0, s38, 57344
    s_nop 0
    buffer_load_dwordx4 v19, s[60:63], s30 offen lds
    s_add_u32 s30, s30, s31
    s_add_u32 m0, s38, 61440
    s_nop 0
    buffer_load_dwordx4 v19, s[60:63], s30 offen lds
    s_add_u32 s30, s30, s31
    s_add_u32 m0, s38, 65536
    s_nop 0
    buffer_load_dwordx4 v19, s[60:63], s30 offen lds
    s_add_u32 s30, s30, s31
    s_add_u32 m0, s38, 69632
    s_nop 0
    buffer_load_dwordx4 v19, s[60:63], s30 offen lds
    s_add_u32 s30, s30, s31
    s_cmp_lg_u32 s33, 2
    s_cbranch_scc1 LN_p_wait
    s_waitcnt vmcnt(12)
    v_lshlrev_b32 v64, 16, v12
    v_and_b32 v65, 0xffff0000, v12
    v_lshlrev_b32 v66, 16, v13
    v_and_b32 v67, 0xffff0000, v13
    v_mul_f32 v68, 0xbfb8aa3b, v64
    v_mul_f32 v69, 0xbfb8aa3b, v65
    v_mul_f32 v70, 0xbfb8aa3b, v66
    v_mul_f32 v71, 0xbfb8aa3b, v67
    v_exp_f32 v68, v68
    v_exp_f32 v69, v69
    v_exp_f32 v70, v70
    v_exp_f32 v71, v71
    v_add_f32 v68, 1.0, v68
    v_add_f32 v69, 1.0, v69
    v_add_f32 v70, 1.0, v70
    v_add_f32 v71, 1.0, v71
    v_rcp_f32 v68, v68
    v_rcp_f32 v69, v69
    v_rcp_f32 v70, v70
    v_rcp_f32 v71, v71
    v_mul_f32 v64, v64, v68
    v_mul_f32 v65, v65, v69
    v_mul_f32 v66, v66, v70
    v_mul_f32 v67, v67, v71
    v_cvt_pk_bf16_f32 v12, v64, v65
    v_cvt_pk_bf16_f32 v13, v66, v67
    ds_write_b64 v9, v[12:13]
LN_p_wait:
    s_waitcnt vmcnt(0) lgkmcnt(0)
    s_barrier
    s_cmp_eq_u32 s33, 2
    s_cbranch_scc1 LN_p_mm_mod
    s_cmp_eq_u32 s33, 1
    s_cbranch_scc1 LN_p_mm_vo
    v_add_u32 v26, s37, v20
    v_add_u32 v27, s37, v21
    v_add_u32 v28, s37, v22
    v_add_u32 v29, s37, v23
    ds_read_b128 v[32:35], v20 offset:0
    ds_read_b128 v[36:39], v20 offset:12288
    ds_read_b128 v[40:43], v26 offset:0
    ds_read_b128 v[44:47], v21 offset:0
    ds_read_b128 v[48:51], v21 offset:12288
    ds_read_b128 v[52:55], v27 offset:0
    ds_read_b128 v[56:59], v22 offset:0
    ds_read_b128 v[60:63], v22 offset:12288
    ds_read_b128 v[64:67], v28 offset:0
    ds_read_b128 v[68:71], v23 offset:0
    ds_read_b128 v[72:75], v23 offset:12288
    ds_read_b128 v[76:79], v29 offset:0
    s_waitcnt lgkmcnt(9)
    v_mfma_f32_16x16x32_bf16 v[80:83], v[32:35], v[40:43], 0
    v_mfma_f32_16x16x32_bf16 v[84:87], v[36:39], v[40:43], 0
    ds_read_b128 v[32:35], v20 offset:256
    ds_read_b128 v[36:39], v20 offset:12544
    ds_read_b128 v[40:43], v26 offset:256
    s_waitcnt lgkmcnt(9)
    v_mfma_f32_16x16x32_bf16 v[80:83], v[44:47], v[52:55], v[80:83]
    v_mfma_f32_16x16x32_bf16 v[84:87], v[48:51], v[52:55], v[84:87]
    ds_read_b128 v[44:47], v21 offset:256
    ds_read_b128 v[48:51], v21 offset:12544
    ds_read_b128 v[52:55], v27 offset:256
    s_waitcnt lgkmcnt(9)
    v_mfma_f32_16x16x32_bf16 v[80:83], v[56:59], v[64:67], v[80:83]
    v_mfma_f32_16x16x32_bf16 v[84:87], v[60:63], v[64:67], v[84:87]
    ds_read_b128 v[56:59], v22 offset:256
    ds_read_b128 v[60:63], v22 offset:12544
    ds_read_b128 v[64:67], v28 offset:256
    s_waitcnt lgkmcnt(9)
    v_mfma_f32_16x16x32_bf16 v[80:83], v[68:71], v[76:79], v[80:83]
    v_mfma_f32_16x16x32_bf16 v[84:87], v[72:75], v[76:79], v[84:87]
    ds_read_b128 v[68:71], v23 offset:256
    ds_read_b128 v[72:75], v23 offset:12544
    ds_read_b128 v[76:79], v29 offset:256
    s_waitcnt lgkmcnt(9)
    v_mfma_f32_16x16x32_bf16 v[80:83], v[32:35], v[40:43], v[80:83]
    v_mfma_f32_16x16x32_bf16 v[84:87], v[36:39], v[40:43], v[84:87]
    ds_read_b128 v[32:35], v20 offset:512
    ds_read_b128 v[36:39], v20 offset:12800
    ds_read_b128 v[40:43], v26 offset:512
    s_waitcnt lgkmcnt(9)
    v_mfma_f32_16x16x32_bf16 v[80:83], v[44:47], v[52:55], v[80:83]
    v_mfma_f32_16x16x32_bf16 v[84:87], v[48:51], v[52:55], v[84:87]
    ds_read_b128 v[44:47], v21 offset:512
    ds_read_b128 v[48:51], v21 offset:12800
    ds_read_b128 v[52:55], v27 offset:512
    s_waitcnt lgkmcnt(9)
    v_mfma_f32_16x16x32_bf16 v[80:83], v[56:59], v[64:67], v[80:83]
    v_mfma_f32_16x16x32_bf16 v[84:87], v[60:63], v[64:67], v[84:87]
    ds_read_b128 v[56:59], v22 offset:512
    ds_read_b128 v[60:63], v22 offset:12800
    ds_read_b128 v[64:67], v28 offset:512
    s_waitcnt lgkmcnt(9)
    v_mfma_f32_16x16x32_bf16 v[80:83], v[68:71], v[76:79], v[80:83]
    v_mfma_f32_16x16x32_bf16 v[84:87], v[72:75], v[76:79], v[84:87]
    ds_read_b128 v[68:71], v23 offset:512
    ds_read_b128 v[72:75], v23 offset:12800
    ds_read_b128 v[76:79], v29 offset:512
    s_waitcnt lgkmcnt(9)
    v_mfma_f32_16x16x32_bf16 v[80:83], v[32:35], v[40:43], v[80:83]
    v_mfma_f32_16x16x32_bf16 v[84:87], v[36:39], v[40:43], v[84:87]
    s_waitcnt lgkmcnt(6)
    v_mfma_f32_16x16x32_bf16 v[80:83], v[44:47], v[52:55], v[80:83]
    v_mfma_f32_16x16x32_bf16 v[84:87], v[48:51], v[52:55], v[84:87]
    s_waitcnt lgkmcnt(3)
    v_mfma_f32_16x16x32_bf16 v[80:83], v[56:59], v[64:67], v[80:83]
    v_mfma_f32_16x16x32_bf16 v[84:87], v[60:63], v[64:67], v[84:87]
    s_waitcnt lgkmcnt(0)
    v_mfma_f32_16x16x32_bf16 v[80:83], v[68:71], v[76:79], v[80:83]
    v_mfma_f32_16x16x32_bf16 v[84:87], v[72:75], v[76:79], v[84:87]
    s_branch LN_p_wst
LN_p_mm_vo:
    ds_read_b128 v[32:35], v20 offset:0
    ds_read_b128 v[36:39], v20 offset:12288
    ds_read_b64_tr_b16 v[40:41], v24 offset:0
    ds_read_b64_tr_b16 v[42:43], v24 offset:512
    ds_read_b128 v[44:47], v21 offset:0
    ds_read_b128 v[48:51], v21 offset:12288
    ds_read_b64_tr_b16 v[52:53], v24 offset:4096
    ds_read_b64_tr_b16 v[54:55], v24 offset:4608
    ds_read_b128 v[56:59], v22 offset:0
    ds_read_b128 v[60:63], v22 offset:12288
    ds_read_b64_tr_b16 v[64:65], v24 offset:8192
    ds_read_b64_tr_b16 v[66:67], v24 offset:8704
    ds_read_b128 v[68:71], v23 offset:0
    ds_read_b128 v[72:75], v23 offset:12288
    ds_read_b64_tr_b16 v[76:77], v24 offset:12288
    ds_read_b64_tr_b16 v[78:79], v24 offset:12800
    s_waitcnt lgkmcnt(12)
    v_mfma_f32_16x16x32_bf16 v[80:83], v[32:35], v[40:43], 0
    v_mfma_f32_16x16x32_bf16 v[84:87], v[36:39], v[40:43], 0
    ds_read_b128 v[32:35], v20 offset:256
    ds_read_b128 v[36:39], v20 offset:12544
    ds_read_b64_tr_b16 v[40:41], v24 offset:16384
    ds_read_b64_tr_b16 v[42:43], v24 offset:16896
    s_waitcnt lgkmcnt(12)
    v_mfma_f32_16x16x32_bf16 v[80:83], v[44:47], v[52:55], v[80:83]
    v_mfma_f32_16x16x32_bf16 v[84:87], v[48:51], v[52:55], v[84:87]
    ds_read_b128 v[44:47], v21 offset:256
    ds_read_b128 v[48:51], v21 offset:12544
    ds_read_b64_tr_b16 v[52:53], v24 offset:20480
    ds_read_b64_tr_b16 v[54:55], v24 offset:20992
    s_waitcnt lgkmcnt(12)
    v_mfma_f32_16x16x32_bf16 v[80:83], v[56:59], v[64:67], v[80:83]
    v_mfma_f32_16x16x32_bf16 v[84:87], v[60:63], v[64:67], v[84:87]
    ds_read_b128 v[56:59], v22 offset:256
    ds_read_b128 v[60:63], v22 offset:12544
    ds_read_b64_tr_b16 v[64:65], v24 offset:24576
    ds_read_b64_tr_b16 v[66:67], v24 offset:25088
    s_waitcnt lgkmcnt(12)
    v_mfma_f32_16x16x32_bf16 v[80:83], v[68:71], v[76:79], v[80:83]
    v_mfma_f32_16x16x32_bf16 v[84:87], v[72:75], v[76:79], v[84:87]
    ds_read_b128 v[68:71], v23 offset:256
    ds_read_b128 v[72:75], v23 offset:12544
    ds_read_b64_tr_b16 v[76:77], v24 offset:28672
    ds_read_b64_tr_b16 v[78:79], v24 offset:29184
    s_waitcnt lgkmcnt(12)
    v_mfma_f32_16x16x32_bf16 v[80:83], v[32:35], v[40:43], v[80:83]
    v_mfma_f32_16x16x32_bf16 v[84:87], v[36:39], v[40:43], v[84:87]
    ds_read_b128 v[32:35], v20 offset:512
    ds_read_b128 v[36:39], v20 offset:12800
    ds_read_b64_tr_b16 v[40:41], v24 offset:32768
    ds_read_b64_tr_b16 v[42:43], v24 offset:33280
    s_waitcnt lgkmcnt(12)
    v_mfma_f32_16x16x32_bf16 v[80:83], v[44:47], v[52:55], v[80:83]
    v_mfma_f32_16x16x32_bf16 v[84:87], v[48:51], v[52:55], v[84:87]
    ds_read_b128 v[44:47], v21 offset:512
    ds_read_b128 v[48:51], v21 offset:12800
    ds_read_b64_tr_b16 v[52:53], v24 offset:36864
    ds_read_b64_tr_b16 v[54:55], v24 offset:37376
    s_waitcnt lgkmcnt(12)
    v_mfma_f32_16x16x32_bf16 v[80:83], v[56:59], v[64:67], v[80:83]
    v_mfma_f32_16x16x32_bf16 v[84:87], v[60:63], v[64:67], v[84:87]
    ds_read_b128 v[56:59], v22 offset:512
    ds_read_b128 v[60:63], v22 offset:12800
    ds_read_b64_tr_b16 v[64:65], v24 offset:40960
    ds_read_b64_tr_b16 v[66:67], v24 offset:41472
    s_waitcnt lgkmcnt(12)
    v_mfma_f32_16x16x32_bf16 v[80:83], v[68:71], v[76:79], v[80:83]
    v_mfma_f32_16x16x32_bf16 v[84:87], v[72:75], v[76:79], v[84:87]
    ds_read_b128 v[68:71], v23 offset:512
    ds_read_b128 v[72:75], v23 offset:12800
    ds_read_b64_tr_b16 v[76:77], v24 offset:45056
    ds_read_b64_tr_b16 v[78:79], v24 offset:45568
    s_waitcnt lgkmcnt(12)
    v_mfma_f32_16x16x32_bf16 v[80:83], v[32:35], v[40:43], v[80:83]
    v_mfma_f32_16x16x32_bf16 v[84:87], v[36:39], v[40:43], v[84:87]
    s_waitcnt lgkmcnt(8)
    v_mfma_f32_16x16x32_bf16 v[80:83], v[44:47], v[52:55], v[80:83]
    v_mfma_f32_16x16x32_bf16 v[84:87], v[48:51], v[52:55], v[84:87]
    s_waitcnt lgkmcnt(4)
    v_mfma_f32_16x16x32_bf16 v[80:83], v[56:59], v[64:67], v[80:83]
    v_mfma_f32_16x16x32_bf16 v[84:87], v[60:63], v[64:67], v[84:87]
    s_waitcnt lgkmcnt(0)
    v_mfma_f32_16x16x32_bf16 v[80:83], v[68:71], v[76:79], v[80:83]
    v_mfma_f32_16x16x32_bf16 v[84:87], v[72:75], v[76:79], v[84:87]
LN_p_wst:
    s_mul_i32 s30, s33, 24
    s_lshl_b32 s31, s35, 2
    s_add_u32 s30, s30, s31
    s_add_u32 s30, s30, s3
    s_mul_i32 s31, s30, 43691
    s_lshr_b32 s31, s31, 18
    s_mul_i32 s32, s31, 6
    s_sub_u32 s30, s30, s32
    s_mul_i32 s31, s31, 12
    s_add_u32 s31, s31, s34
    s_mul_i32 s31, s31, 6
    s_add_u32 s30, s30, s31
    s_lshl_b32 s30, s30, 10
    s_add_u32 s30, s30, 2097152
    v_lshrrev_b32 v9, 1, v7
    v_lshlrev_b32 v9, 8, v9
    v_lshl_add_u32 v9, v6, 4, v9
    v_and_b32 v10, 1, v7
    v_lshl_add_u32 v9, v10, 3, v9
    v_cvt_pk_bf16_f32 v20, v80, v81
    v_cvt_pk_bf16_f32 v21, v82, v83
    v_cvt_pk_bf16_f32 v22, v84, v85
    v_cvt_pk_bf16_f32 v23, v86, v87
    buffer_store_dwordx2 v[20:21], v9, s[20:23], s30 offen
    buffer_store_dwordx2 v[22:23], v9, s[20:23], s30 offen offset:512
    s_branch LN_p_fin
LN_p_mm_mod:
    v_and_b32 v25, 1, v6
    v_mul_u32_u24 v25, 768, v25
    v_lshl_add_u32 v25, v7, 4, v25
    ds_read_b128 v[32:35], v25 offset:0
    ds_read_b64_tr_b16 v[40:41], v24 offset:0
    ds_read_b64_tr_b16 v[42:43], v24 offset:512
    ds_read_b128 v[44:47], v25 offset:64
    ds_read_b64_tr_b16 v[52:53], v24 offset:4096
    ds_read_b64_tr_b16 v[54:55], v24 offset:4608
    ds_read_b128 v[56:59], v25 offset:128
    ds_read_b64_tr_b16 v[64:65], v24 offset:8192
    ds_read_b64_tr_b16 v[66:67], v24 offset:8704
    ds_read_b128 v[68:71], v25 offset:192
    ds_read_b64_tr_b16 v[76:77], v24 offset:12288
    ds_read_b64_tr_b16 v[78:79], v24 offset:12800
    s_waitcnt lgkmcnt(9)
    v_mfma_f32_16x16x32_bf16 v[80:83], v[32:35], v[40:43], 0
    ds_read_b128 v[32:35], v25 offset:256
    ds_read_b64_tr_b16 v[40:41], v24 offset:16384
    ds_read_b64_tr_b16 v[42:43], v24 offset:16896
    s_waitcnt lgkmcnt(9)
    v_mfma_f32_16x16x32_bf16 v[80:83], v[44:47], v[52:55], v[80:83]
    ds_read_b128 v[44:47], v25 offset:320
    ds_read_b64_tr_b16 v[52:53], v24 offset:20480
    ds_read_b64_tr_b16 v[54:55], v24 offset:20992
    s_waitcnt lgkmcnt(9)
    v_mfma_f32_16x16x32_bf16 v[80:83], v[56:59], v[64:67], v[80:83]
    ds_read_b128 v[56:59], v25 offset:384
    ds_read_b64_tr_b16 v[64:65], v24 offset:24576
    ds_read_b64_tr_b16 v[66:67], v24 offset:25088
    s_waitcnt lgkmcnt(9)
    v_mfma_f32_16x16x32_bf16 v[80:83], v[68:71], v[76:79], v[80:83]
    ds_read_b128 v[68:71], v25 offset:448
    ds_read_b64_tr_b16 v[76:77], v24 offset:28672
    ds_read_b64_tr_b16 v[78:79], v24 offset:29184
    s_waitcnt lgkmcnt(9)
    v_mfma_f32_16x16x32_bf16 v[80:83], v[32:35], v[40:43], v[80:83]
    ds_read_b128 v[32:35], v25 offset:512
    ds_read_b64_tr_b16 v[40:41], v24 offset:32768
    ds_read_b64_tr_b16 v[42:43], v24 offset:33280
    s_waitcnt lgkmcnt(9)
    v_mfma_f32_16x16x32_bf16 v[80:83], v[44:47], v[52:55], v[80:83]
    ds_read_b128 v[44:47], v25 offset:576
    ds_read_b64_tr_b16 v[52:53], v24 offset:36864
    ds_read_b64_tr_b16 v[54:55], v24 offset:37376
    s_waitcnt lgkmcnt(9)
    v_mfma_f32_16x16x32_bf16 v[80:83], v[56:59], v[64:67], v[80:83]
    ds_read_b128 v[56:59], v25 offset:640
    ds_read_b64_tr_b16 v[64:65], v24 offset:40960
    ds_read_b64_tr_b16 v[66:67], v24 offset:41472
    s_waitcnt lgkmcnt(9)
    v_mfma_f32_16x16x32_bf16 v[80:83], v[68:71], v[76:79], v[80:83]
    ds_read_b128 v[68:71], v25 offset:704
    ds_read_b64_tr_b16 v[76:77], v24 offset:45056
    ds_read_b64_tr_b16 v[78:79], v24 offset:45568
    s_waitcnt lgkmcnt(9)
    v_mfma_f32_16x16x32_bf16 v[80:83], v[32:35], v[40:43], v[80:83]
    s_waitcnt lgkmcnt(6)
    v_mfma_f32_16x16x32_bf16 v[80:83], v[44:47], v[52:55], v[80:83]
    s_waitcnt lgkmcnt(3)
    v_mfma_f32_16x16x32_bf16 v[80:83], v[56:59], v[64:67], v[80:83]
    s_waitcnt lgkmcnt(0)
    v_mfma_f32_16x16x32_bf16 v[80:83], v[68:71], v[76:79], v[80:83]
    s_nop 7
    v_cvt_pk_bf16_f32 v22, v80, v81
    v_lshlrev_b32 v20, 16, v22
    v_and_b32 v21, 0xffff0000, v22
    s_mul_i32 s30, s35, 43691
    s_lshr_b32 s30, s30, 18
    s_mul_i32 s31, s30, 6
    s_sub_u32 s31, s35, s31
    s_lshl_b32 s31, s31, 6
    s_lshl_b32 s32, s3, 4
    s_add_u32 s31, s31, s32
    v_add_u32 v9, s31, v1
    v_lshrrev_b32 v11, 3, v9
    v_and_b32 v10, 7, v9
    v_lshlrev_b32 v11, 6, v11
    v_lshl_add_u32 v10, v10, 2, v11
    v_lshlrev_b32 v9, 2, v9
    s_mov_b32 s32, 3145728
    s_mov_b64 exec, 0xffff
    s_cmp_eq_u32 s30, 1
    s_cbranch_scc1 LN_p_scale
    s_cmp_eq_u32 s30, 2
    s_cbranch_scc1 LN_p_gate
    buffer_store_dword v20, v10, s[20:23], s32 offen offset:32
    buffer_store_dword v21, v10, s[20:23], s32 offen offset:3104
    s_branch LN_p_modend
LN_p_scale:
    v_add_f32 v20, 1.0, v20
    v_add_f32 v21, 1.0, v21
    v_cvt_pk_bf16_f32 v22, v20, v21
    v_lshlrev_b32 v20, 16, v22
    v_and_b32 v21, 0xffff0000, v22
    v_mul_f32 v22, 0x3d96c740, v20
    v_mul_f32 v23, 0x3d96c740, v21
    s_mov_b32 s31, 3153920
    buffer_store_dword v20, v10, s[20:23], s32 offen
    buffer_store_dword v21, v10, s[20:23], s32 offen offset:3072
    buffer_store_dword v22, v9, s[20:23], s31 offen
    buffer_store_dword v23, v9, s[20:23], s31 offen offset:1536
    s_branch LN_p_modend
LN_p_gate:
    s_mov_b32 s31, 3158016
    buffer_store_dword v20, v9, s[20:23], s31 offen
    buffer_store_dword v21, v9, s[20:23], s31 offen offset:1536
LN_p_modend:
    s_mov_b64 exec, -1
    s_branch LN_p_fin
LN_p_ln:
    s_lshr_b32 s32, s2, 3
    s_lshl_b32 s29, s79, 4
    s_add_u32 s32, s32, s29
    s_getpc_b64 s[30:31]
LN_p_pc:
    s_lshl_b32 s33, s32, 2
    s_add_u32 s33, s33, s3
    v_mul_u32_u24 v8, 768, v7
    v_lshl_add_u32 v8, v6, 4, v8
    s_mul_i32 s40, s33, 3072
    v_mov_b32 v100, -1
    v_mov_b32 v101, -1
    v_mov_b32 v102, -1
    v_mov_b32 v103, -1
    v_lshrrev_b32 v9, 1, v6
    v_lshlrev_b32 v9, 10, v9
    v_and_b32 v10, 1, v6
    v_lshl_add_u32 v9, v10, 9, v9
    v_lshl_add_u32 v9, v7, 4, v9
    s_lshr_b32 s29, s33, 3
    s_mul_i32 s29, s29, 24576
    s_and_b32 s34, s33, 7
    s_lshl_b32 s34, s34, 6
    s_add_u32 s29, s29, s34
    s_add_u32 s41, s29, 0
    s_lshr_b32 s34, s33, 5
    s_lshl_b32 s34, s34, 2
    s_add_u32 s34, s34, s3
    s_and_b32 s34, s34, 31
    s_lshl_b32 s34, s34, 10
    s_min_u32 s34, s34, LN_codeend-main_kernel-1024
    s_add_u32 s34, s34, main_kernel-LN_p_pc
    s_add_u32 s30, s30, s34
    s_addc_u32 s31, s31, 0
    s_waitcnt lgkmcnt(0)
    s_mov_b32 s44, s4
    s_and_b32 s45, s5, 0xffff
    s_mov_b32 s46, 1572864
    s_mov_b32 s47, 0x00020000
    buffer_load_dwordx4 v[16:19], v8, s[44:47], s40 offen offset:0
    buffer_load_dwordx4 v[20:23], v8, s[44:47], s40 offen offset:256
    buffer_load_dwordx4 v[24:27], v8, s[44:47], s40 offen offset:512
    global_load_dword v4, v2, s[30:31]
    s_mov_b32 s20, s18
    s_and_b32 s21, s19, 0xffff
    s_mov_b32 s22, 29360128
    s_mov_b32 s23, 0x00020000
    s_mov_b32 s24, s18
    s_and_b32 s25, s19, 0xffff
    s_mov_b32 s26, 7405568
    s_mov_b32 s27, 0x00020000
    s_waitcnt vmcnt(1)
    v_lshlrev_b32 v64, 16, v16
    v_and_b32 v65, 0xffff0000, v16
    v_lshlrev_b32 v66, 16, v17
    v_and_b32 v67, 0xffff0000, v17
    v_lshlrev_b32 v68, 16, v18
    v_and_b32 v69, 0xffff0000, v18
    v_lshlrev_b32 v70, 16, v19
    v_and_b32 v71, 0xffff0000, v19
    v_lshlrev_b32 v72, 16, v20
    v_and_b32 v73, 0xffff0000, v20
    v_lshlrev_b32 v74, 16, v21
    v_and_b32 v75, 0xffff0000, v21
    v_lshlrev_b32 v76, 16, v22
    v_and_b32 v77, 0xffff0000, v22
    v_lshlrev_b32 v78, 16, v23
    v_and_b32 v79, 0xffff0000, v23
    v_lshlrev_b32 v80, 16, v24
    v_and_b32 v81, 0xffff0000, v24
    v_lshlrev_b32 v82, 16, v25
    v_and_b32 v83, 0xffff0000, v25
    v_lshlrev_b32 v84, 16, v26
    v_and_b32 v85, 0xffff0000, v26
    v_lshlrev_b32 v86, 16, v27
    v_and_b32 v87, 0xffff0000, v27
    v_pk_add_f32 v[88:89], v[64:65], v[66:67]
    v_pk_add_f32 v[90:91], v[68:69], v[70:71]
    v_pk_add_f32 v[92:93], v[72:73], v[74:75]
    v_pk_add_f32 v[94:95], v[76:77], v[78:79]
    v_pk_add_f32 v[96:97], v[80:81], v[82:83]
    v_pk_add_f32 v[98:99], v[84:85], v[86:87]
    v_pk_add_f32 v[88:89], v[88:89], v[94:95]
    v_pk_add_f32 v[90:91], v[90:91], v[96:97]
    v_pk_add_f32 v[92:93], v[92:93], v[98:99]
    v_pk_add_f32 v[88:89], v[88:89], v[90:91]
    v_pk_add_f32 v[88:89], v[88:89], v[92:93]
    v_add_f32 v88, v88, v89
    s_nop 1
    v_add_f32_dpp v88, v88, v88 row_ror:8 row_mask:0xf bank_mask:0xf
    s_nop 1
    v_add_f32_dpp v88, v88, v88 row_ror:4 row_mask:0xf bank_mask:0xf
    s_nop 1
    v_add_f32_dpp v88, v88, v88 row_ror:2 row_mask:0xf bank_mask:0xf
    s_nop 1
    v_add_f32_dpp v88, v88, v88 row_ror:1 row_mask:0xf bank_mask:0xf
    v_mul_f32 v88, 0x3b2aaaab, v88
    v_cvt_pk_bf16_f32 v89, v88, v88
    v_lshlrev_b32 v89, 16, v89
    v_pk_add_f32 v[64:65], v[64:65], v[88:89] op_sel:[0,1] op_sel_hi:[1,1] neg_lo:[0,1] neg_hi:[0,1]
    v_pk_add_f32 v[66:67], v[66:67], v[88:89] op_sel:[0,1] op_sel_hi:[1,1] neg_lo:[0,1] neg_hi:[0,1]
    v_pk_add_f32 v[68:69], v[68:69], v[88:89] op_sel:[0,1] op_sel_hi:[1,1] neg_lo:[0,1] neg_hi:[0,1]
    v_pk_add_f32 v[70:71], v[70:71], v[88:89] op_sel:[0,1] op_sel_hi:[1,1] neg_lo:[0,1] neg_hi:[0,1]
    v_pk_add_f32 v[72:73], v[72:73], v[88:89] op_sel:[0,1] op_sel_hi:[1,1] neg_lo:[0,1] neg_hi:[0,1]
    v_pk_add_f32 v[74:75], v[74:75], v[88:89] op_sel:[0,1] op_sel_hi:[1,1] neg_lo:[0,1] neg_hi:[0,1]
    v_pk_add_f32 v[76:77], v[76:77], v[88:89] op_sel:[0,1] op_sel_hi:[1,1] neg_lo:[0,1] neg_hi:[0,1]
    v_pk_add_f32 v[78:79], v[78:79], v[88:89] op_sel:[0,1] op_sel_hi:[1,1] neg_lo:[0,1] neg_hi:[0,1]
    v_pk_add_f32 v[80:81], v[80:81], v[88:89] op_sel:[0,1] op_sel_hi:[1,1] neg_lo:[0,1] neg_hi:[0,1]
    v_pk_add_f32 v[82:83], v[82:83], v[88:89] op_sel:[0,1] op_sel_hi:[1,1] neg_lo:[0,1] neg_hi:[0,1]
    v_pk_add_f32 v[84:85], v[84:85], v[88:89] op_sel:[0,1] op_sel_hi:[1,1] neg_lo:[0,1] neg_hi:[0,1]
    v_pk_add_f32 v[86:87], v[86:87], v[88:89] op_sel:[0,1] op_sel_hi:[1,1] neg_lo:[0,1] neg_hi:[0,1]
    v_pk_mul_f32 v[90:91], v[64:65], v[64:65]
    v_pk_mul_f32 v[92:93], v[66:67], v[66:67]
    v_pk_fma_f32 v[90:91], v[68:69], v[68:69], v[90:91]
    v_pk_fma_f32 v[92:93], v[70:71], v[70:71], v[92:93]
    v_pk_fma_f32 v[90:91], v[72:73], v[72:73], v[90:91]
    v_pk_fma_f32 v[92:93], v[74:75], v[74:75], v[92:93]
    v_pk_fma_f32 v[90:91], v[76:77], v[76:77], v[90:91]
    v_pk_fma_f32 v[92:93], v[78:79], v[78:79], v[92:93]
    v_pk_fma_f32 v[90:91], v[80:81], v[80:81], v[90:91]
    v_pk_fma_f32 v[92:93], v[82:83], v[82:83], v[92:93]
    v_pk_fma_f32 v[90:91], v[84:85], v[84:85], v[90:91]
    v_pk_fma_f32 v[92:93], v[86:87], v[86:87], v[92:93]
    v_cvt_pk_bf16_f32 v16, v64, v65
    v_cvt_pk_bf16_f32 v17, v66, v67
    v_cvt_pk_bf16_f32 v18, v68, v69
    v_cvt_pk_bf16_f32 v19, v70, v71
    v_cvt_pk_bf16_f32 v20, v72, v73
    v_cvt_pk_bf16_f32 v21, v74, v75
    v_cvt_pk_bf16_f32 v22, v76, v77
    v_cvt_pk_bf16_f32 v23, v78, v79
    v_cvt_pk_bf16_f32 v24, v80, v81
    v_cvt_pk_bf16_f32 v25, v82, v83
    v_cvt_pk_bf16_f32 v26, v84, v85
    v_cvt_pk_bf16_f32 v27, v86, v87
    v_pk_add_f32 v[90:91], v[90:91], v[92:93]
    v_sub_f32 v88, v88, v89
    v_add_f32 v90, v90, v91
    s_nop 1
    v_add_f32_dpp v90, v90, v90 row_ror:8 row_mask:0xf bank_mask:0xf
    s_nop 1
    v_add_f32_dpp v90, v90, v90 row_ror:4 row_mask:0xf bank_mask:0xf
    s_nop 1
    v_add_f32_dpp v90, v90, v90 row_ror:2 row_mask:0xf bank_mask:0xf
    s_nop 1
    v_add_f32_dpp v90, v90, v90 row_ror:1 row_mask:0xf bank_mask:0xf
    v_lshlrev_b32 v64, 16, v16
    v_and_b32 v65, 0xffff0000, v16
    v_lshlrev_b32 v66, 16, v17
    v_and_b32 v67, 0xffff0000, v17
    v_lshlrev_b32 v68, 16, v18
    v_and_b32 v69, 0xffff0000, v18
    v_lshlrev_b32 v70, 16, v19
    v_and_b32 v71, 0xffff0000, v19
    v_lshlrev_b32 v72, 16, v20
    v_and_b32 v73, 0xffff0000, v20
    v_lshlrev_b32 v74, 16, v21
    v_and_b32 v75, 0xffff0000, v21
    v_lshlrev_b32 v76, 16, v22
    v_and_b32 v77, 0xffff0000, v22
    v_lshlrev_b32 v78, 16, v23
    v_and_b32 v79, 0xffff0000, v23
    v_lshlrev_b32 v80, 16, v24
    v_and_b32 v81, 0xffff0000, v24
    v_lshlrev_b32 v82, 16, v25
    v_and_b32 v83, 0xffff0000, v25
    v_lshlrev_b32 v84, 16, v26
    v_and_b32 v85, 0xffff0000, v26
    v_lshlrev_b32 v86, 16, v27
    v_and_b32 v87, 0xffff0000, v27
    v_mul_f32 v90, 0x3b2aaaab, v90
    v_fma_f32 v90, -v88, v88, v90
    v_max_f32 v90, 0, v90
    v_cvt_pk_bf16_f32 v90, v90, v90
    v_lshlrev_b32 v90, 16, v90
    v_add_f32 v90, 0x3727c5ac, v90
    v_cvt_pk_bf16_f32 v90, v90, v90
    v_lshlrev_b32 v90, 16, v90
    v_sqrt_f32 v90, v90
    s_nop 0
    v_cvt_pk_bf16_f32 v90, v90, v90
    v_lshlrev_b32 v90, 16, v90
    v_rcp_f32 v90, v90
    s_nop 0
    v_pk_mul_f32 v[64:65], v[64:65], v[90:91] op_sel_hi:[1,0]
    v_pk_mul_f32 v[66:67], v[66:67], v[90:91] op_sel_hi:[1,0]
    v_pk_mul_f32 v[68:69], v[68:69], v[90:91] op_sel_hi:[1,0]
    v_pk_mul_f32 v[70:71], v[70:71], v[90:91] op_sel_hi:[1,0]
    v_cvt_pk_bf16_f32 v16, v64, v65
    v_cvt_pk_bf16_f32 v17, v66, v67
    v_cvt_pk_bf16_f32 v18, v68, v69
    v_cvt_pk_bf16_f32 v19, v70, v71
    s_add_u32 s30, s41, 0
    buffer_store_dwordx4 v[16:19], v9, s[20:23], s30 offen
    v_pk_mul_f32 v[72:73], v[72:73], v[90:91] op_sel_hi:[1,0]
    v_pk_mul_f32 v[74:75], v[74:75], v[90:91] op_sel_hi:[1,0]
    v_pk_mul_f32 v[76:77], v[76:77], v[90:91] op_sel_hi:[1,0]
    v_pk_mul_f32 v[78:79], v[78:79], v[90:91] op_sel_hi:[1,0]
    v_cvt_pk_bf16_f32 v20, v72, v73
    v_cvt_pk_bf16_f32 v21, v74, v75
    v_cvt_pk_bf16_f32 v22, v76, v77
    v_cvt_pk_bf16_f32 v23, v78, v79
    s_add_u32 s30, s41, 8192
    buffer_store_dwordx4 v[20:23], v9, s[20:23], s30 offen
    v_pk_mul_f32 v[80:81], v[80:81], v[90:91] op_sel_hi:[1,0]
    v_pk_mul_f32 v[82:83], v[82:83], v[90:91] op_sel_hi:[1,0]
    v_pk_mul_f32 v[84:85], v[84:85], v[90:91] op_sel_hi:[1,0]
    v_pk_mul_f32 v[86:87], v[86:87], v[90:91] op_sel_hi:[1,0]
    v_cvt_pk_bf16_f32 v24, v80, v81
    v_cvt_pk_bf16_f32 v25, v82, v83
    v_cvt_pk_bf16_f32 v26, v84, v85
    v_cvt_pk_bf16_f32 v27, v86, v87
    s_add_u32 s30, s41, 16384
    buffer_store_dwordx4 v[24:27], v9, s[20:23], s30 offen
    s_mul_i32 s35, s33, 1024
    s_add_u32 s35, s35, 7340032
    buffer_store_dwordx4 v[100:103], v2, s[24:27], s35 offen offset:0 sc1
    s_cmp_ge_u32 s33, 24
    s_cbranch_scc1 LN_p_noz
    v_mov_b32 v68, 0
    v_mov_b32 v69, 0
    v_mov_b32 v70, 0
    v_mov_b32 v71, 0
    s_lshl_b32 s35, s33, 10
    s_add_u32 s35, s35, 7405568
    buffer_store_dwordx4 v[68:71], v2, s[20:23], s35 offen sc1
LN_p_noz:
LN_p_fin:
LN_p_exit:
    s_endpgm
.globl main_kernel
.p2align 8
.type main_kernel,@function
main_kernel:
    s_cmp_ge_u32 s2, 256
    s_cbranch_scc1 LN_exit
    s_load_dwordx16 s[4:19], s[0:1], 0
    v_and_b32 v1, 63, v0
    v_lshrrev_b32 v2, 6, v0
    s_lshr_b32 s78, s2, 3
    v_readfirstlane_b32 s3, v2
    v_lshlrev_b32 v2, 4, v1
    s_and_b32 s79, s2, 7
    s_lshr_b32 s24, s79, 2
    s_and_b32 s29, s79, 3
    s_lshl_b32 s29, s29, 2
    s_and_b32 s30, s78, 3
    s_add_u32 s25, s29, s30
    s_lshr_b32 s26, s2, 5
    s_lshl_b32 s27, s24, 4
    s_add_u32 s27, s27, s25
    v_and_b32 v6, 15, v1
    v_lshrrev_b32 v7, 4, v1
    s_and_b32 s34, s3, 1
    s_lshr_b32 s35, s3, 1
    s_mov_b32 s94, 512
    s_mov_b32 s95, 512
    s_mul_i32 s84, s24, 48
    s_mul_i32 s30, s3, 12
    s_add_u32 s84, s84, s30
    s_lshl_b32 s84, s84, 6
    s_add_u32 s84, s84, 3145728
    s_lshl_b32 s85, s3, 10
    s_add_u32 s85, s85, 122880
    v_lshrrev_b32 v5, 1, v7
    v_lshlrev_b32 v5, 10, v5
    v_and_b32 v9, 1, v7
    v_lshl_add_u32 v5, v9, 9, v5
    v_lshl_add_u32 v8, v6, 4, v5
    s_mul_i32 s36, s27, 49152
    s_mul_i32 s30, s3, 6144
    s_add_u32 s36, s36, s30
    s_add_u32 s36, s36, 0
    s_mul_i32 s86, s26, 73728
    s_add_u32 s86, s86, s30
    s_add_u32 s86, s86, 2097152
    s_add_u32 s87, s30, 0
    s_and_b32 s29, s26, 3
    s_mul_i32 s29, s29, 96
    s_mul_i32 s30, s35, 48
    s_add_u32 s29, s29, s30
    s_mul_i32 s30, s24, 384
    s_add_u32 s29, s29, s30
    s_lshl_b32 s29, s29, 2
    s_add_u32 s88, s29, 3153920
    s_lshl_b32 s29, s24, 5
    s_lshl_b32 s30, s26, 2
    s_add_u32 s29, s29, s30
    s_add_u32 s29, s29, s3
    s_mul_i32 s29, s29, 24576
    s_add_u32 s76, s29, 0
    v_lshlrev_b32 v12, 4, v7
    v_lshlrev_b32 v13, 6, v7
    v_add_u32 v13, s85, v13
    s_mul_i32 s29, s3, 3072
    s_add_u32 s29, s29, 73728
    v_add_u32 v11, s29, v2
    s_waitcnt lgkmcnt(0)
    s_mov_b32 s20, s18
    s_and_b32 s21, s19, 0xffff
    s_mov_b32 s22, 29360128
    s_mov_b32 s23, 0x00020000
    s_getreg_b32 s67, hwreg(HW_REG_XCC_ID, 0, 4)
    s_add_u32 s67, s67, 1
    s_lshl_b32 s29, s27, 7
    s_add_u32 s29, s29, 7421952
    v_and_b32 v14, 7, v1
    v_lshl_add_u32 v14, v14, 2, s29
    s_cmp_lg_u32 s3, 3
    s_cbranch_scc1 LN_noxi
    s_lshl_b32 s30, s26, 2
    s_add_u32 s29, s29, s30
    v_mov_b32 v4, s29
    v_mov_b32 v5, s67
    s_mov_b64 exec, 1
    buffer_store_dword v5, v4, s[20:23], 0 offen sc1
    s_mov_b64 exec, -1
LN_noxi:
    s_mov_b32 m0, s85
    s_nop 0
    buffer_load_dwordx4 v2, s[20:23], s84 offen lds
    s_add_u32 s33, s36, 0
    buffer_load_dwordx4 v[16:19], v8, s[20:23], s33 offen
    s_add_u32 s33, s36, 256
    buffer_load_dwordx4 v[20:23], v8, s[20:23], s33 offen
    s_add_u32 s33, s36, 24576
    buffer_load_dwordx4 v[24:27], v8, s[20:23], s33 offen
    s_add_u32 s33, s36, 24832
    buffer_load_dwordx4 v[28:31], v8, s[20:23], s33 offen
    s_add_u32 s33, s36, 2048
    buffer_load_dwordx4 v[32:35], v8, s[20:23], s33 offen
    s_add_u32 s33, s36, 2304
    buffer_load_dwordx4 v[36:39], v8, s[20:23], s33 offen
    s_add_u32 s33, s36, 26624
    buffer_load_dwordx4 v[40:43], v8, s[20:23], s33 offen
    s_add_u32 s33, s36, 26880
    buffer_load_dwordx4 v[44:47], v8, s[20:23], s33 offen
    s_add_u32 s33, s36, 4096
    buffer_load_dwordx4 v[48:51], v8, s[20:23], s33 offen
    s_add_u32 s33, s36, 4352
    buffer_load_dwordx4 v[52:55], v8, s[20:23], s33 offen
    s_add_u32 s33, s36, 28672
    buffer_load_dwordx4 v[56:59], v8, s[20:23], s33 offen
    s_add_u32 s33, s36, 28928
    buffer_load_dwordx4 v[60:63], v8, s[20:23], s33 offen
    s_add_u32 m0, s87, 0
    s_add_u32 s32, s86, 0
    buffer_load_dwordx4 v2, s[20:23], s32 offen offset:0  lds
    buffer_load_dwordx4 v2, s[20:23], s32 offen offset:1024  lds
    buffer_load_dwordx4 v2, s[20:23], s32 offen offset:2048  lds
    buffer_load_dwordx4 v2, s[20:23], s32 offen offset:3072  lds
    s_add_u32 m0, s87, 4096
    s_add_u32 s32, s86, 4096
    buffer_load_dwordx4 v2, s[20:23], s32 offen offset:0  lds
    buffer_load_dwordx4 v2, s[20:23], s32 offen offset:1024  lds
    s_mov_b32 s44, s4
    s_and_b32 s45, s5, 0xffff
    s_mov_b32 s46, 1572864
    s_mov_b32 s47, 0x00020000
    s_mov_b32 s48, s14
    s_and_b32 s49, s15, 0xffff
    s_mov_b32 s50, 1572864
    s_mov_b32 s51, 0x00020000
    s_lshl_b32 s29, s24, 6
    s_lshl_b32 s30, s25, 2
    s_add_u32 s29, s29, s30
    s_lshl_b32 s97, s29, 15
    s_add_u32 s97, s97, 8388608
    s_lshl_b32 s30, s26, 2
    s_add_u32 s30, s30, s3
    s_lshl_b32 s30, s30, 10
    s_add_u32 s96, s97, s30
    s_mul_i32 s29, s24, 24
    s_mul_i32 s30, s26, 3
    s_add_u32 s29, s29, s30
    s_lshl_b32 s89, s29, 15
    s_add_u32 s89, s89, 5767168
    v_mov_b32 v120, -1
    v_mov_b32 v121, -1
    v_mov_b32 v122, -1
    v_mov_b32 v123, -1
    s_lshl_b32 s29, s27, 7
    s_add_u32 s100, s29, 7417856
    s_lshl_b32 s30, s26, 2
    s_add_u32 s82, s100, s30
    v_mov_b32 v124, s82
    s_mov_b64 s[98:99], 1
    s_mov_b32 s69, 1024
    s_lshl_b32 s29, s27, 1
    s_add_u32 s29, s29, s34
    s_mul_i32 s29, s29, 24
    s_mul_i32 s30, s26, 6
    s_add_u32 s29, s29, s30
    s_mul_i32 s31, s35, 3
    s_add_u32 s29, s29, s31
    s_lshl_b32 s29, s29, 10
    s_add_u32 s65, s29, 4194304
    s_lshl_b32 s29, s27, 7
    s_lshl_b32 s30, s26, 4
    s_add_u32 s29, s29, s30
    s_lshl_b32 s30, s3, 2
    s_add_u32 s29, s29, s30
    s_add_u32 s64, s29, 7405568
    s_cmp_lt_u32 s26, 4
    s_cbranch_scc1 LN_ob
    s_sub_u32 s29, s26, 4
    s_mul_i32 s30, s29, 6
    s_mul_i32 s31, s35, 3
    s_add_u32 s30, s30, s31
    s_mul_i32 s31, s24, 24
    s_add_u32 s30, s30, s31
    s_lshl_b32 s30, s30, 5
    s_lshl_b32 s31, s25, 1
    s_add_u32 s30, s30, s31
    s_add_u32 s30, s30, s34
    s_lshl_b32 s30, s30, 10
    s_add_u32 s65, s30, 5767168
    s_lshl_b32 s30, s24, 3
    s_lshl_b32 s31, s29, 1
    s_add_u32 s30, s30, s31
    s_add_u32 s30, s30, s35
    s_lshl_b32 s30, s30, 8
    s_lshl_b32 s31, s25, 3
    s_add_u32 s30, s30, s31
    s_lshl_b32 s31, s34, 2
    s_add_u32 s30, s30, s31
    s_add_u32 s64, s30, 7409664
    s_mov_b32 s69, 32768
    s_lshl_b32 s30, s24, 3
    s_lshl_b32 s31, s29, 1
    s_add_u32 s30, s30, s31
    s_lshl_b32 s30, s30, 8
    s_lshl_b32 s31, s25, 2
    s_add_u32 s30, s30, s31
    s_add_u32 s30, s30, 7409536
    v_lshlrev_b32 v124, 8, v1
    v_add_u32 v124, s30, v124
    v_writelane_b32 v124, s82, 0
    s_mov_b64 s[98:99], 7
LN_ob:
    s_waitcnt vmcnt(18)
    ds_read_b128 v[64:67], v13 offset:0
    ds_read_b128 v[68:71], v13 offset:16
    ds_read_b128 v[72:75], v13 offset:32
    ds_read_b128 v[76:79], v13 offset:48
    ds_read_b128 v[80:83], v13 offset:256
    ds_read_b128 v[84:87], v13 offset:272
    ds_read_b128 v[88:91], v13 offset:288
    ds_read_b128 v[92:95], v13 offset:304
    ds_read_b128 v[96:99], v13 offset:512
    ds_read_b128 v[100:103], v13 offset:528
    ds_read_b128 v[104:107], v13 offset:544
    ds_read_b128 v[108:111], v13 offset:560
    s_add_u32 m0, s87, 24576
    s_add_u32 s32, s86, 24576
    buffer_load_dwordx4 v2, s[20:23], s32 offen offset:0  lds
    s_waitcnt vmcnt(18)
    s_waitcnt lgkmcnt(8)
    v_lshlrev_b32 v112, 16, v16
    v_and_b32 v113, 0xffff0000, v16
    v_lshlrev_b32 v114, 16, v17
    v_and_b32 v115, 0xffff0000, v17
    v_lshlrev_b32 v116, 16, v18
    v_and_b32 v117, 0xffff0000, v18
    v_lshlrev_b32 v118, 16, v19
    v_and_b32 v119, 0xffff0000, v19
    v_pk_fma_f32 v[112:113], v[112:113], v[64:65], v[72:73]
    v_pk_fma_f32 v[114:115], v[114:115], v[66:67], v[74:75]
    v_pk_fma_f32 v[116:117], v[116:117], v[68:69], v[76:77]
    v_pk_fma_f32 v[118:119], v[118:119], v[70:71], v[78:79]
    v_cvt_pk_bf16_f32 v16, v112, v113
    v_cvt_pk_bf16_f32 v17, v114, v115
    v_cvt_pk_bf16_f32 v18, v116, v117
    v_cvt_pk_bf16_f32 v19, v118, v119
    ds_write_b128 v11, v[16:19] offset:0
    buffer_load_dwordx4 v2, s[20:23], s32 offen offset:1024  lds
    s_waitcnt vmcnt(18)
    v_lshlrev_b32 v112, 16, v20
    v_and_b32 v113, 0xffff0000, v20
    v_lshlrev_b32 v114, 16, v21
    v_and_b32 v115, 0xffff0000, v21
    v_lshlrev_b32 v116, 16, v22
    v_and_b32 v117, 0xffff0000, v22
    v_lshlrev_b32 v118, 16, v23
    v_and_b32 v119, 0xffff0000, v23
    v_pk_fma_f32 v[112:113], v[112:113], v[64:65], v[72:73]
    v_pk_fma_f32 v[114:115], v[114:115], v[66:67], v[74:75]
    v_pk_fma_f32 v[116:117], v[116:117], v[68:69], v[76:77]
    v_pk_fma_f32 v[118:119], v[118:119], v[70:71], v[78:79]
    v_cvt_pk_bf16_f32 v20, v112, v113
    v_cvt_pk_bf16_f32 v21, v114, v115
    v_cvt_pk_bf16_f32 v22, v116, v117
    v_cvt_pk_bf16_f32 v23, v118, v119
    ds_write_b128 v11, v[20:23] offset:12288
    buffer_load_dwordx4 v2, s[20:23], s32 offen offset:2048  lds
    s_waitcnt vmcnt(18)
    v_lshlrev_b32 v112, 16, v24
    v_and_b32 v113, 0xffff0000, v24
    v_lshlrev_b32 v114, 16, v25
    v_and_b32 v115, 0xffff0000, v25
    v_lshlrev_b32 v116, 16, v26
    v_and_b32 v117, 0xffff0000, v26
    v_lshlrev_b32 v118, 16, v27
    v_and_b32 v119, 0xffff0000, v27
    v_pk_fma_f32 v[112:113], v[112:113], v[64:65], v[72:73]
    v_pk_fma_f32 v[114:115], v[114:115], v[66:67], v[74:75]
    v_pk_fma_f32 v[116:117], v[116:117], v[68:69], v[76:77]
    v_pk_fma_f32 v[118:119], v[118:119], v[70:71], v[78:79]
    v_cvt_pk_bf16_f32 v24, v112, v113
    v_cvt_pk_bf16_f32 v25, v114, v115
    v_cvt_pk_bf16_f32 v26, v116, v117
    v_cvt_pk_bf16_f32 v27, v118, v119
    ds_write_b128 v11, v[24:27] offset:24576
    buffer_load_dwordx4 v2, s[20:23], s32 offen offset:3072  lds
    s_waitcnt vmcnt(18)
    v_lshlrev_b32 v112, 16, v28
    v_and_b32 v113, 0xffff0000, v28
    v_lshlrev_b32 v114, 16, v29
    v_and_b32 v115, 0xffff0000, v29
    v_lshlrev_b32 v116, 16, v30
    v_and_b32 v117, 0xffff0000, v30
    v_lshlrev_b32 v118, 16, v31
    v_and_b32 v119, 0xffff0000, v31
    v_pk_fma_f32 v[112:113], v[112:113], v[64:65], v[72:73]
    v_pk_fma_f32 v[114:115], v[114:115], v[66:67], v[74:75]
    v_pk_fma_f32 v[116:117], v[116:117], v[68:69], v[76:77]
    v_pk_fma_f32 v[118:119], v[118:119], v[70:71], v[78:79]
    v_cvt_pk_bf16_f32 v28, v112, v113
    v_cvt_pk_bf16_f32 v29, v114, v115
    v_cvt_pk_bf16_f32 v30, v116, v117
    v_cvt_pk_bf16_f32 v31, v118, v119
    ds_write_b128 v11, v[28:31] offset:36864
    s_add_u32 m0, s87, 28672
    s_add_u32 s32, s86, 28672
    buffer_load_dwordx4 v2, s[20:23], s32 offen offset:0  lds
    s_waitcnt vmcnt(18)
    s_waitcnt lgkmcnt(8)
    v_lshlrev_b32 v112, 16, v32
    v_and_b32 v113, 0xffff0000, v32
    v_lshlrev_b32 v114, 16, v33
    v_and_b32 v115, 0xffff0000, v33
    v_lshlrev_b32 v116, 16, v34
    v_and_b32 v117, 0xffff0000, v34
    v_lshlrev_b32 v118, 16, v35
    v_and_b32 v119, 0xffff0000, v35
    v_pk_fma_f32 v[112:113], v[112:113], v[80:81], v[88:89]
    v_pk_fma_f32 v[114:115], v[114:115], v[82:83], v[90:91]
    v_pk_fma_f32 v[116:117], v[116:117], v[84:85], v[92:93]
    v_pk_fma_f32 v[118:119], v[118:119], v[86:87], v[94:95]
    v_cvt_pk_bf16_f32 v32, v112, v113
    v_cvt_pk_bf16_f32 v33, v114, v115
    v_cvt_pk_bf16_f32 v34, v116, v117
    v_cvt_pk_bf16_f32 v35, v118, v119
    ds_write_b128 v11, v[32:35] offset:1024
    buffer_load_dwordx4 v2, s[20:23], s32 offen offset:1024  lds
    s_waitcnt vmcnt(18)
    v_lshlrev_b32 v112, 16, v36
    v_and_b32 v113, 0xffff0000, v36
    v_lshlrev_b32 v114, 16, v37
    v_and_b32 v115, 0xffff0000, v37
    v_lshlrev_b32 v116, 16, v38
    v_and_b32 v117, 0xffff0000, v38
    v_lshlrev_b32 v118, 16, v39
    v_and_b32 v119, 0xffff0000, v39
    v_pk_fma_f32 v[112:113], v[112:113], v[80:81], v[88:89]
    v_pk_fma_f32 v[114:115], v[114:115], v[82:83], v[90:91]
    v_pk_fma_f32 v[116:117], v[116:117], v[84:85], v[92:93]
    v_pk_fma_f32 v[118:119], v[118:119], v[86:87], v[94:95]
    v_cvt_pk_bf16_f32 v36, v112, v113
    v_cvt_pk_bf16_f32 v37, v114, v115
    v_cvt_pk_bf16_f32 v38, v116, v117
    v_cvt_pk_bf16_f32 v39, v118, v119
    ds_write_b128 v11, v[36:39] offset:13312
    s_add_u32 m0, s87, 49152
    s_add_u32 s32, s86, 49152
    buffer_load_dwordx4 v2, s[20:23], s32 offen offset:0  lds
    s_waitcnt vmcnt(18)
    v_lshlrev_b32 v112, 16, v40
    v_and_b32 v113, 0xffff0000, v40
    v_lshlrev_b32 v114, 16, v41
    v_and_b32 v115, 0xffff0000, v41
    v_lshlrev_b32 v116, 16, v42
    v_and_b32 v117, 0xffff0000, v42
    v_lshlrev_b32 v118, 16, v43
    v_and_b32 v119, 0xffff0000, v43
    v_pk_fma_f32 v[112:113], v[112:113], v[80:81], v[88:89]
    v_pk_fma_f32 v[114:115], v[114:115], v[82:83], v[90:91]
    v_pk_fma_f32 v[116:117], v[116:117], v[84:85], v[92:93]
    v_pk_fma_f32 v[118:119], v[118:119], v[86:87], v[94:95]
    v_cvt_pk_bf16_f32 v40, v112, v113
    v_cvt_pk_bf16_f32 v41, v114, v115
    v_cvt_pk_bf16_f32 v42, v116, v117
    v_cvt_pk_bf16_f32 v43, v118, v119
    ds_write_b128 v11, v[40:43] offset:25600
    buffer_load_dwordx4 v2, s[20:23], s32 offen offset:1024  lds
    s_waitcnt vmcnt(18)
    v_lshlrev_b32 v112, 16, v44
    v_and_b32 v113, 0xffff0000, v44
    v_lshlrev_b32 v114, 16, v45
    v_and_b32 v115, 0xffff0000, v45
    v_lshlrev_b32 v116, 16, v46
    v_and_b32 v117, 0xffff0000, v46
    v_lshlrev_b32 v118, 16, v47
    v_and_b32 v119, 0xffff0000, v47
    v_pk_fma_f32 v[112:113], v[112:113], v[80:81], v[88:89]
    v_pk_fma_f32 v[114:115], v[114:115], v[82:83], v[90:91]
    v_pk_fma_f32 v[116:117], v[116:117], v[84:85], v[92:93]
    v_pk_fma_f32 v[118:119], v[118:119], v[86:87], v[94:95]
    v_cvt_pk_bf16_f32 v44, v112, v113
    v_cvt_pk_bf16_f32 v45, v114, v115
    v_cvt_pk_bf16_f32 v46, v116, v117
    v_cvt_pk_bf16_f32 v47, v118, v119
    ds_write_b128 v11, v[44:47] offset:37888
    buffer_load_dwordx4 v2, s[20:23], s32 offen offset:2048  lds
    s_waitcnt vmcnt(18)
    s_waitcnt lgkmcnt(8)
    v_lshlrev_b32 v112, 16, v48
    v_and_b32 v113, 0xffff0000, v48
    v_lshlrev_b32 v114, 16, v49
    v_and_b32 v115, 0xffff0000, v49
    v_lshlrev_b32 v116, 16, v50
    v_and_b32 v117, 0xffff0000, v50
    v_lshlrev_b32 v118, 16, v51
    v_and_b32 v119, 0xffff0000, v51
    v_pk_fma_f32 v[112:113], v[112:113], v[96:97], v[104:105]
    v_pk_fma_f32 v[114:115], v[114:115], v[98:99], v[106:107]
    v_pk_fma_f32 v[116:117], v[116:117], v[100:101], v[108:109]
    v_pk_fma_f32 v[118:119], v[118:119], v[102:103], v[110:111]
    v_cvt_pk_bf16_f32 v48, v112, v113
    v_cvt_pk_bf16_f32 v49, v114, v115
    v_cvt_pk_bf16_f32 v50, v116, v117
    v_cvt_pk_bf16_f32 v51, v118, v119
    ds_write_b128 v11, v[48:51] offset:2048
    buffer_load_dwordx4 v2, s[20:23], s32 offen offset:3072  lds
    s_waitcnt vmcnt(18)
    v_lshlrev_b32 v112, 16, v52
    v_and_b32 v113, 0xffff0000, v52
    v_lshlrev_b32 v114, 16, v53
    v_and_b32 v115, 0xffff0000, v53
    v_lshlrev_b32 v116, 16, v54
    v_and_b32 v117, 0xffff0000, v54
    v_lshlrev_b32 v118, 16, v55
    v_and_b32 v119, 0xffff0000, v55
    v_pk_fma_f32 v[112:113], v[112:113], v[96:97], v[104:105]
    v_pk_fma_f32 v[114:115], v[114:115], v[98:99], v[106:107]
    v_pk_fma_f32 v[116:117], v[116:117], v[100:101], v[108:109]
    v_pk_fma_f32 v[118:119], v[118:119], v[102:103], v[110:111]
    v_cvt_pk_bf16_f32 v52, v112, v113
    v_cvt_pk_bf16_f32 v53, v114, v115
    v_cvt_pk_bf16_f32 v54, v116, v117
    v_cvt_pk_bf16_f32 v55, v118, v119
    ds_write_b128 v11, v[52:55] offset:14336
    s_add_u32 m0, s87, 53248
    s_add_u32 s32, s86, 53248
    buffer_load_dwordx4 v2, s[20:23], s32 offen offset:0  lds
    s_waitcnt vmcnt(18)
    v_lshlrev_b32 v112, 16, v56
    v_and_b32 v113, 0xffff0000, v56
    v_lshlrev_b32 v114, 16, v57
    v_and_b32 v115, 0xffff0000, v57
    v_lshlrev_b32 v116, 16, v58
    v_and_b32 v117, 0xffff0000, v58
    v_lshlrev_b32 v118, 16, v59
    v_and_b32 v119, 0xffff0000, v59
    v_pk_fma_f32 v[112:113], v[112:113], v[96:97], v[104:105]
    v_pk_fma_f32 v[114:115], v[114:115], v[98:99], v[106:107]
    v_pk_fma_f32 v[116:117], v[116:117], v[100:101], v[108:109]
    v_pk_fma_f32 v[118:119], v[118:119], v[102:103], v[110:111]
    v_cvt_pk_bf16_f32 v56, v112, v113
    v_cvt_pk_bf16_f32 v57, v114, v115
    v_cvt_pk_bf16_f32 v58, v116, v117
    v_cvt_pk_bf16_f32 v59, v118, v119
    ds_write_b128 v11, v[56:59] offset:26624
    buffer_load_dwordx4 v2, s[20:23], s32 offen offset:1024  lds
    s_waitcnt vmcnt(18)
    v_lshlrev_b32 v112, 16, v60
    v_and_b32 v113, 0xffff0000, v60
    v_lshlrev_b32 v114, 16, v61
    v_and_b32 v115, 0xffff0000, v61
    v_lshlrev_b32 v116, 16, v62
    v_and_b32 v117, 0xffff0000, v62
    v_lshlrev_b32 v118, 16, v63
    v_and_b32 v119, 0xffff0000, v63
    v_pk_fma_f32 v[112:113], v[112:113], v[96:97], v[104:105]
    v_pk_fma_f32 v[114:115], v[114:115], v[98:99], v[106:107]
    v_pk_fma_f32 v[116:117], v[116:117], v[100:101], v[108:109]
    v_pk_fma_f32 v[118:119], v[118:119], v[102:103], v[110:111]
    v_cvt_pk_bf16_f32 v60, v112, v113
    v_cvt_pk_bf16_f32 v61, v114, v115
    v_cvt_pk_bf16_f32 v62, v116, v117
    v_cvt_pk_bf16_f32 v63, v118, v119
    ds_write_b128 v11, v[60:63] offset:38912
    buffer_load_dwordx4 v[224:227], v12, s[20:23], s88 offen offset:0
    buffer_load_dwordx4 v[228:231], v12, s[20:23], s88 offen offset:64
    buffer_load_dwordx4 v[232:235], v12, s[20:23], s88 offen offset:128
    s_add_u32 s30, s96, 0
    buffer_store_dwordx4 v[120:123], v2, s[20:23], s30 offen sc1
    s_add_u32 s30, s96, 32768
    buffer_store_dwordx4 v[120:123], v2, s[20:23], s30 offen sc1
    s_add_u32 s30, s96, 65536
    buffer_store_dwordx4 v[120:123], v2, s[20:23], s30 offen sc1
    s_add_u32 s30, s96, 98304
    buffer_store_dwordx4 v[120:123], v2, s[20:23], s30 offen sc1
    s_mov_b32 s30, s65
    buffer_store_dwordx4 v[120:123], v2, s[20:23], s30 offen sc1
    s_add_u32 s30, s30, s69
    buffer_store_dwordx4 v[120:123], v2, s[20:23], s30 offen sc1
    s_add_u32 s30, s30, s69
    buffer_store_dwordx4 v[120:123], v2, s[20:23], s30 offen sc1
    s_add_u32 s30, s30, s69
    s_mul_i32 s29, s34, 24576
    s_add_u32 s29, s29, 73728
    v_add_u32 v8, s29, v2
    s_mul_i32 s29, s35, 3072
    s_add_u32 s29, s29, 0
    v_add_u32 v10, s29, v2
    v_add_u32 v13, 36864, v10
    s_waitcnt vmcnt(22) lgkmcnt(0)
    s_barrier
    s_cmp_ge_u32 s26, 4
    s_cbranch_scc1 LN_g_v
    ds_read_b128 v[16:19], v8 offset:0
    ds_read_b128 v[20:23], v8 offset:12288
    ds_read_b128 v[24:27], v10 offset:0
    ds_read_b128 v[28:31], v10 offset:1024
    ds_read_b128 v[32:35], v10 offset:2048
    ds_read_b128 v[36:39], v8 offset:1024
    ds_read_b128 v[40:43], v8 offset:13312
    ds_read_b128 v[44:47], v10 offset:6144
    ds_read_b128 v[48:51], v10 offset:7168
    ds_read_b128 v[52:55], v10 offset:8192
    s_waitcnt lgkmcnt(5)
    v_mfma_f32_16x16x32_bf16 v[80:83], v[24:27], v[16:19], 0
    ds_read_b128 v[56:59], v8 offset:2048
    v_mfma_f32_16x16x32_bf16 v[84:87], v[24:27], v[20:23], 0
    ds_read_b128 v[60:63], v8 offset:14336
    v_mfma_f32_16x16x32_bf16 v[88:91], v[28:31], v[16:19], 0
    ds_read_b128 v[64:67], v10 offset:12288
    v_mfma_f32_16x16x32_bf16 v[92:95], v[28:31], v[20:23], 0
    ds_read_b128 v[68:71], v10 offset:13312
    v_mfma_f32_16x16x32_bf16 v[96:99], v[32:35], v[16:19], 0
    ds_read_b128 v[72:75], v10 offset:14336
    v_mfma_f32_16x16x32_bf16 v[100:103], v[32:35], v[20:23], 0
    s_add_u32 s77, s76, 0
    buffer_load_dwordx4 a[0:3], v2, s[20:23], s77 offen offset:0
    buffer_load_dwordx4 a[4:7], v2, s[20:23], s77 offen offset:1024
    s_waitcnt lgkmcnt(5)
    v_mfma_f32_16x16x32_bf16 v[80:83], v[44:47], v[36:39], v[80:83]
    ds_read_b128 v[16:19], v8 offset:3072
    v_mfma_f32_16x16x32_bf16 v[84:87], v[44:47], v[40:43], v[84:87]
    ds_read_b128 v[20:23], v8 offset:15360
    v_mfma_f32_16x16x32_bf16 v[88:91], v[48:51], v[36:39], v[88:91]
    ds_read_b128 v[24:27], v10 offset:18432
    v_mfma_f32_16x16x32_bf16 v[92:95], v[48:51], v[40:43], v[92:95]
    ds_read_b128 v[28:31], v10 offset:19456
    v_mfma_f32_16x16x32_bf16 v[96:99], v[52:55], v[36:39], v[96:99]
    ds_read_b128 v[32:35], v10 offset:20480
    v_mfma_f32_16x16x32_bf16 v[100:103], v[52:55], v[40:43], v[100:103]
    buffer_load_dwordx4 a[8:11], v2, s[20:23], s77 offen offset:2048
    buffer_load_dwordx4 a[12:15], v2, s[20:23], s77 offen offset:3072
    s_waitcnt vmcnt(20)
    s_barrier
    s_waitcnt lgkmcnt(5)
    v_mfma_f32_16x16x32_bf16 v[80:83], v[64:67], v[56:59], v[80:83]
    ds_read_b128 v[36:39], v8 offset:4096
    v_mfma_f32_16x16x32_bf16 v[84:87], v[64:67], v[60:63], v[84:87]
    ds_read_b128 v[40:43], v8 offset:16384
    v_mfma_f32_16x16x32_bf16 v[88:91], v[68:71], v[56:59], v[88:91]
    ds_read_b128 v[44:47], v10 offset:24576
    v_mfma_f32_16x16x32_bf16 v[92:95], v[68:71], v[60:63], v[92:95]
    ds_read_b128 v[48:51], v10 offset:25600
    v_mfma_f32_16x16x32_bf16 v[96:99], v[72:75], v[56:59], v[96:99]
    ds_read_b128 v[52:55], v10 offset:26624
    v_mfma_f32_16x16x32_bf16 v[100:103], v[72:75], v[60:63], v[100:103]
    s_add_u32 s77, s76, 4096
    buffer_load_dwordx4 a[16:19], v2, s[20:23], s77 offen offset:0
    buffer_load_dwordx4 a[20:23], v2, s[20:23], s77 offen offset:1024
    s_waitcnt lgkmcnt(5)
    v_mfma_f32_16x16x32_bf16 v[80:83], v[24:27], v[16:19], v[80:83]
    ds_read_b128 v[56:59], v8 offset:5120
    v_mfma_f32_16x16x32_bf16 v[84:87], v[24:27], v[20:23], v[84:87]
    ds_read_b128 v[60:63], v8 offset:17408
    v_mfma_f32_16x16x32_bf16 v[88:91], v[28:31], v[16:19], v[88:91]
    ds_read_b128 v[64:67], v10 offset:30720
    v_mfma_f32_16x16x32_bf16 v[92:95], v[28:31], v[20:23], v[92:95]
    ds_read_b128 v[68:71], v10 offset:31744
    v_mfma_f32_16x16x32_bf16 v[96:99], v[32:35], v[16:19], v[96:99]
    ds_read_b128 v[72:75], v10 offset:32768
    v_mfma_f32_16x16x32_bf16 v[100:103], v[32:35], v[20:23], v[100:103]
    buffer_load_dwordx4 a[24:27], v2, s[20:23], s77 offen offset:2048
    buffer_load_dwordx4 a[28:31], v2, s[20:23], s77 offen offset:3072
    s_waitcnt lgkmcnt(5)
    v_mfma_f32_16x16x32_bf16 v[80:83], v[44:47], v[36:39], v[80:83]
    ds_read_b128 v[16:19], v8 offset:6144
    v_mfma_f32_16x16x32_bf16 v[84:87], v[44:47], v[40:43], v[84:87]
    ds_read_b128 v[20:23], v8 offset:18432
    v_mfma_f32_16x16x32_bf16 v[88:91], v[48:51], v[36:39], v[88:91]
    ds_read_b128 v[24:27], v13 offset:0
    v_mfma_f32_16x16x32_bf16 v[92:95], v[48:51], v[40:43], v[92:95]
    ds_read_b128 v[28:31], v13 offset:1024
    v_mfma_f32_16x16x32_bf16 v[96:99], v[52:55], v[36:39], v[96:99]
    ds_read_b128 v[32:35], v13 offset:2048
    v_mfma_f32_16x16x32_bf16 v[100:103], v[52:55], v[40:43], v[100:103]
    s_add_u32 s77, s76, 8192
    buffer_load_dwordx4 a[32:35], v2, s[20:23], s77 offen offset:0
    buffer_load_dwordx4 a[36:39], v2, s[20:23], s77 offen offset:1024
    s_waitcnt lgkmcnt(5)
    v_mfma_f32_16x16x32_bf16 v[80:83], v[64:67], v[56:59], v[80:83]
    ds_read_b128 v[36:39], v8 offset:7168
    v_mfma_f32_16x16x32_bf16 v[84:87], v[64:67], v[60:63], v[84:87]
    ds_read_b128 v[40:43], v8 offset:19456
    v_mfma_f32_16x16x32_bf16 v[88:91], v[68:71], v[56:59], v[88:91]
    ds_read_b128 v[44:47], v13 offset:6144
    v_mfma_f32_16x16x32_bf16 v[92:95], v[68:71], v[60:63], v[92:95]
    ds_read_b128 v[48:51], v13 offset:7168
    v_mfma_f32_16x16x32_bf16 v[96:99], v[72:75], v[56:59], v[96:99]
    ds_read_b128 v[52:55], v13 offset:8192
    v_mfma_f32_16x16x32_bf16 v[100:103], v[72:75], v[60:63], v[100:103]
    buffer_load_dwordx4 a[40:43], v2, s[20:23], s77 offen offset:2048
    buffer_load_dwordx4 a[44:47], v2, s[20:23], s77 offen offset:3072
    s_waitcnt vmcnt(12)
    s_barrier
    s_cmp_lg_u32 s3, 3
    s_cbranch_scc1 LN_nofr0
    v_mov_b32 v5, 1
    s_mov_b64 exec, s[98:99]
    buffer_store_dword v5, v124, s[20:23], 0 offen sc1
    s_mov_b64 exec, -1
LN_nofr0:
    buffer_load_dword v3, v14, s[20:23], 0 offen sc1
    s_waitcnt lgkmcnt(5)
    v_mfma_f32_16x16x32_bf16 v[80:83], v[24:27], v[16:19], v[80:83]
    ds_read_b128 v[56:59], v8 offset:8192
    v_mfma_f32_16x16x32_bf16 v[84:87], v[24:27], v[20:23], v[84:87]
    ds_read_b128 v[60:63], v8 offset:20480
    v_mfma_f32_16x16x32_bf16 v[88:91], v[28:31], v[16:19], v[88:91]
    ds_read_b128 v[64:67], v13 offset:12288
    v_mfma_f32_16x16x32_bf16 v[92:95], v[28:31], v[20:23], v[92:95]
    ds_read_b128 v[68:71], v13 offset:13312
    v_mfma_f32_16x16x32_bf16 v[96:99], v[32:35], v[16:19], v[96:99]
    ds_read_b128 v[72:75], v13 offset:14336
    v_mfma_f32_16x16x32_bf16 v[100:103], v[32:35], v[20:23], v[100:103]
    s_add_u32 s77, s76, 12288
    buffer_load_dwordx4 a[48:51], v2, s[20:23], s77 offen offset:0
    buffer_load_dwordx4 a[52:55], v2, s[20:23], s77 offen offset:1024
    s_waitcnt lgkmcnt(5)
    v_mfma_f32_16x16x32_bf16 v[80:83], v[44:47], v[36:39], v[80:83]
    ds_read_b128 v[16:19], v8 offset:9216
    v_mfma_f32_16x16x32_bf16 v[84:87], v[44:47], v[40:43], v[84:87]
    ds_read_b128 v[20:23], v8 offset:21504
    v_mfma_f32_16x16x32_bf16 v[88:91], v[48:51], v[36:39], v[88:91]
    ds_read_b128 v[24:27], v13 offset:18432
    v_mfma_f32_16x16x32_bf16 v[92:95], v[48:51], v[40:43], v[92:95]
    ds_read_b128 v[28:31], v13 offset:19456
    v_mfma_f32_16x16x32_bf16 v[96:99], v[52:55], v[36:39], v[96:99]
    ds_read_b128 v[32:35], v13 offset:20480
    v_mfma_f32_16x16x32_bf16 v[100:103], v[52:55], v[40:43], v[100:103]
    buffer_load_dwordx4 a[56:59], v2, s[20:23], s77 offen offset:2048
    buffer_load_dwordx4 a[60:63], v2, s[20:23], s77 offen offset:3072
    s_waitcnt lgkmcnt(5)
    v_mfma_f32_16x16x32_bf16 v[80:83], v[64:67], v[56:59], v[80:83]
    ds_read_b128 v[36:39], v8 offset:10240
    v_mfma_f32_16x16x32_bf16 v[84:87], v[64:67], v[60:63], v[84:87]
    ds_read_b128 v[40:43], v8 offset:22528
    v_mfma_f32_16x16x32_bf16 v[88:91], v[68:71], v[56:59], v[88:91]
    ds_read_b128 v[44:47], v13 offset:24576
    v_mfma_f32_16x16x32_bf16 v[92:95], v[68:71], v[60:63], v[92:95]
    ds_read_b128 v[48:51], v13 offset:25600
    v_mfma_f32_16x16x32_bf16 v[96:99], v[72:75], v[56:59], v[96:99]
    ds_read_b128 v[52:55], v13 offset:26624
    v_mfma_f32_16x16x32_bf16 v[100:103], v[72:75], v[60:63], v[100:103]
    s_add_u32 s77, s76, 16384
    buffer_load_dwordx4 a[64:67], v2, s[20:23], s77 offen offset:0
    buffer_load_dwordx4 a[68:71], v2, s[20:23], s77 offen offset:1024
    s_waitcnt lgkmcnt(5)
    v_mfma_f32_16x16x32_bf16 v[80:83], v[24:27], v[16:19], v[80:83]
    ds_read_b128 v[56:59], v8 offset:11264
    v_mfma_f32_16x16x32_bf16 v[84:87], v[24:27], v[20:23], v[84:87]
    ds_read_b128 v[60:63], v8 offset:23552
    v_mfma_f32_16x16x32_bf16 v[88:91], v[28:31], v[16:19], v[88:91]
    ds_read_b128 v[64:67], v13 offset:30720
    v_mfma_f32_16x16x32_bf16 v[92:95], v[28:31], v[20:23], v[92:95]
    ds_read_b128 v[68:71], v13 offset:31744
    v_mfma_f32_16x16x32_bf16 v[96:99], v[32:35], v[16:19], v[96:99]
    ds_read_b128 v[72:75], v13 offset:32768
    v_mfma_f32_16x16x32_bf16 v[100:103], v[32:35], v[20:23], v[100:103]
    buffer_load_dwordx4 a[72:75], v2, s[20:23], s77 offen offset:2048
    buffer_load_dwordx4 a[76:79], v2, s[20:23], s77 offen offset:3072
    s_waitcnt lgkmcnt(5)
    v_mfma_f32_16x16x32_bf16 v[80:83], v[44:47], v[36:39], v[80:83]
    v_mfma_f32_16x16x32_bf16 v[84:87], v[44:47], v[40:43], v[84:87]
    v_mfma_f32_16x16x32_bf16 v[88:91], v[48:51], v[36:39], v[88:91]
    v_mfma_f32_16x16x32_bf16 v[92:95], v[48:51], v[40:43], v[92:95]
    v_mfma_f32_16x16x32_bf16 v[96:99], v[52:55], v[36:39], v[96:99]
    v_mfma_f32_16x16x32_bf16 v[100:103], v[52:55], v[40:43], v[100:103]
    s_add_u32 s77, s76, 20480
    buffer_load_dwordx4 a[80:83], v2, s[20:23], s77 offen offset:0
    buffer_load_dwordx4 a[84:87], v2, s[20:23], s77 offen offset:1024
    s_waitcnt lgkmcnt(0)
    v_mfma_f32_16x16x32_bf16 v[80:83], v[64:67], v[56:59], v[80:83]
    v_mfma_f32_16x16x32_bf16 v[84:87], v[64:67], v[60:63], v[84:87]
    v_mfma_f32_16x16x32_bf16 v[88:91], v[68:71], v[56:59], v[88:91]
    v_mfma_f32_16x16x32_bf16 v[92:95], v[68:71], v[60:63], v[92:95]
    v_mfma_f32_16x16x32_bf16 v[96:99], v[72:75], v[56:59], v[96:99]
    v_mfma_f32_16x16x32_bf16 v[100:103], v[72:75], v[60:63], v[100:103]
    buffer_load_dwordx4 a[88:91], v2, s[20:23], s77 offen offset:2048
    buffer_load_dwordx4 a[92:95], v2, s[20:23], s77 offen offset:3072
    s_waitcnt vmcnt(12)
    v_lshrrev_b32 v12, 1, v7
    v_lshlrev_b32 v12, 9, v12
    v_lshl_add_u32 v12, v6, 4, v12
    v_and_b32 v11, 1, v7
    v_lshl_add_u32 v12, v11, 3, v12
    v_cmp_ne_u32 vcc, s67, v3
    v_pk_mul_f32 v[80:81], v[80:81], v[224:225]
    v_pk_mul_f32 v[82:83], v[82:83], v[226:227]
    v_pk_mul_f32 v[84:85], v[84:85], v[224:225]
    v_pk_mul_f32 v[86:87], v[86:87], v[226:227]
    v_pk_mul_f32 v[88:89], v[88:89], v[228:229]
    v_pk_mul_f32 v[90:91], v[90:91], v[230:231]
    v_pk_mul_f32 v[92:93], v[92:93], v[228:229]
    v_pk_mul_f32 v[94:95], v[94:95], v[230:231]
    v_pk_mul_f32 v[96:97], v[96:97], v[232:233]
    v_pk_mul_f32 v[98:99], v[98:99], v[234:235]
    v_pk_mul_f32 v[100:101], v[100:101], v[232:233]
    v_pk_mul_f32 v[102:103], v[102:103], v[234:235]
    v_cvt_pk_bf16_f32 v80, v80, v81
    v_cvt_pk_bf16_f32 v81, v82, v83
    v_cvt_pk_bf16_f32 v84, v84, v85
    v_cvt_pk_bf16_f32 v85, v86, v87
    v_cvt_pk_bf16_f32 v88, v88, v89
    v_cvt_pk_bf16_f32 v89, v90, v91
    v_cvt_pk_bf16_f32 v92, v92, v93
    v_cvt_pk_bf16_f32 v93, v94, v95
    v_cvt_pk_bf16_f32 v96, v96, v97
    v_cvt_pk_bf16_f32 v97, v98, v99
    v_cvt_pk_bf16_f32 v100, v100, v101
    v_cvt_pk_bf16_f32 v101, v102, v103
    s_cbranch_vccnz LN_t_far
    buffer_store_dwordx2 v[80:81], v12, s[20:23], s65 offen offset:0
    buffer_store_dwordx2 v[84:85], v12, s[20:23], s65 offen offset:256
    buffer_store_dwordx2 v[88:89], v12, s[20:23], s65 offen offset:1024
    buffer_store_dwordx2 v[92:93], v12, s[20:23], s65 offen offset:1280
    buffer_store_dwordx2 v[96:97], v12, s[20:23], s65 offen offset:2048
    buffer_store_dwordx2 v[100:101], v12, s[20:23], s65 offen offset:2304
    v_mov_b32 v4, s64
    v_mov_b32 v5, 1
    s_mov_b64 exec, 1
    buffer_store_dword v5, v4, s[20:23], 0 offen
    s_mov_b64 exec, -1
    s_branch LN_g_done2
LN_t_far:
    buffer_store_dwordx2 v[80:81], v12, s[20:23], s65 offen offset:0 sc1
    buffer_store_dwordx2 v[84:85], v12, s[20:23], s65 offen offset:256 sc1
    buffer_store_dwordx2 v[88:89], v12, s[20:23], s65 offen offset:1024 sc1
    buffer_store_dwordx2 v[92:93], v12, s[20:23], s65 offen offset:1280 sc1
    buffer_store_dwordx2 v[96:97], v12, s[20:23], s65 offen offset:2048 sc1
    buffer_store_dwordx2 v[100:101], v12, s[20:23], s65 offen offset:2304 sc1
    v_mov_b32 v4, s64
    v_mov_b32 v5, 1
    s_mov_b64 exec, 1
    buffer_store_dword v5, v4, s[20:23], 0 offen sc1
    s_mov_b64 exec, -1
    s_branch LN_g_done2
LN_g_v:
    ds_read_b128 v[16:19], v8 offset:0
    ds_read_b128 v[20:23], v8 offset:12288
    ds_read_b128 v[24:27], v10 offset:0
    ds_read_b128 v[28:31], v10 offset:1024
    ds_read_b128 v[32:35], v10 offset:2048
    ds_read_b128 v[36:39], v8 offset:1024
    ds_read_b128 v[40:43], v8 offset:13312
    ds_read_b128 v[44:47], v10 offset:6144
    ds_read_b128 v[48:51], v10 offset:7168
    ds_read_b128 v[52:55], v10 offset:8192
    s_waitcnt lgkmcnt(5)
    v_mfma_f32_16x16x32_bf16 v[80:83], v[16:19], v[24:27], 0
    ds_read_b128 v[56:59], v8 offset:2048
    v_mfma_f32_16x16x32_bf16 v[84:87], v[20:23], v[24:27], 0
    ds_read_b128 v[60:63], v8 offset:14336
    v_mfma_f32_16x16x32_bf16 v[88:91], v[16:19], v[28:31], 0
    ds_read_b128 v[64:67], v10 offset:12288
    v_mfma_f32_16x16x32_bf16 v[92:95], v[20:23], v[28:31], 0
    ds_read_b128 v[68:71], v10 offset:13312
    v_mfma_f32_16x16x32_bf16 v[96:99], v[16:19], v[32:35], 0
    ds_read_b128 v[72:75], v10 offset:14336
    v_mfma_f32_16x16x32_bf16 v[100:103], v[20:23], v[32:35], 0
    s_add_u32 s77, s76, 0
    buffer_load_dwordx4 a[0:3], v2, s[20:23], s77 offen offset:0
    buffer_load_dwordx4 a[4:7], v2, s[20:23], s77 offen offset:1024
    s_waitcnt lgkmcnt(5)
    v_mfma_f32_16x16x32_bf16 v[80:83], v[36:39], v[44:47], v[80:83]
    ds_read_b128 v[16:19], v8 offset:3072
    v_mfma_f32_16x16x32_bf16 v[84:87], v[40:43], v[44:47], v[84:87]
    ds_read_b128 v[20:23], v8 offset:15360
    v_mfma_f32_16x16x32_bf16 v[88:91], v[36:39], v[48:51], v[88:91]
    ds_read_b128 v[24:27], v10 offset:18432
    v_mfma_f32_16x16x32_bf16 v[92:95], v[40:43], v[48:51], v[92:95]
    ds_read_b128 v[28:31], v10 offset:19456
    v_mfma_f32_16x16x32_bf16 v[96:99], v[36:39], v[52:55], v[96:99]
    ds_read_b128 v[32:35], v10 offset:20480
    v_mfma_f32_16x16x32_bf16 v[100:103], v[40:43], v[52:55], v[100:103]
    buffer_load_dwordx4 a[8:11], v2, s[20:23], s77 offen offset:2048
    buffer_load_dwordx4 a[12:15], v2, s[20:23], s77 offen offset:3072
    s_waitcnt vmcnt(20)
    s_barrier
    s_waitcnt lgkmcnt(5)
    v_mfma_f32_16x16x32_bf16 v[80:83], v[56:59], v[64:67], v[80:83]
    ds_read_b128 v[36:39], v8 offset:4096
    v_mfma_f32_16x16x32_bf16 v[84:87], v[60:63], v[64:67], v[84:87]
    ds_read_b128 v[40:43], v8 offset:16384
    v_mfma_f32_16x16x32_bf16 v[88:91], v[56:59], v[68:71], v[88:91]
    ds_read_b128 v[44:47], v10 offset:24576
    v_mfma_f32_16x16x32_bf16 v[92:95], v[60:63], v[68:71], v[92:95]
    ds_read_b128 v[48:51], v10 offset:25600
    v_mfma_f32_16x16x32_bf16 v[96:99], v[56:59], v[72:75], v[96:99]
    ds_read_b128 v[52:55], v10 offset:26624
    v_mfma_f32_16x16x32_bf16 v[100:103], v[60:63], v[72:75], v[100:103]
    s_add_u32 s77, s76, 4096
    buffer_load_dwordx4 a[16:19], v2, s[20:23], s77 offen offset:0
    buffer_load_dwordx4 a[20:23], v2, s[20:23], s77 offen offset:1024
    s_waitcnt lgkmcnt(5)
    v_mfma_f32_16x16x32_bf16 v[80:83], v[16:19], v[24:27], v[80:83]
    ds_read_b128 v[56:59], v8 offset:5120
    v_mfma_f32_16x16x32_bf16 v[84:87], v[20:23], v[24:27], v[84:87]
    ds_read_b128 v[60:63], v8 offset:17408
    v_mfma_f32_16x16x32_bf16 v[88:91], v[16:19], v[28:31], v[88:91]
    ds_read_b128 v[64:67], v10 offset:30720
    v_mfma_f32_16x16x32_bf16 v[92:95], v[20:23], v[28:31], v[92:95]
    ds_read_b128 v[68:71], v10 offset:31744
    v_mfma_f32_16x16x32_bf16 v[96:99], v[16:19], v[32:35], v[96:99]
    ds_read_b128 v[72:75], v10 offset:32768
    v_mfma_f32_16x16x32_bf16 v[100:103], v[20:23], v[32:35], v[100:103]
    buffer_load_dwordx4 a[24:27], v2, s[20:23], s77 offen offset:2048
    buffer_load_dwordx4 a[28:31], v2, s[20:23], s77 offen offset:3072
    s_waitcnt lgkmcnt(5)
    v_mfma_f32_16x16x32_bf16 v[80:83], v[36:39], v[44:47], v[80:83]
    ds_read_b128 v[16:19], v8 offset:6144
    v_mfma_f32_16x16x32_bf16 v[84:87], v[40:43], v[44:47], v[84:87]
    ds_read_b128 v[20:23], v8 offset:18432
    v_mfma_f32_16x16x32_bf16 v[88:91], v[36:39], v[48:51], v[88:91]
    ds_read_b128 v[24:27], v13 offset:0
    v_mfma_f32_16x16x32_bf16 v[92:95], v[40:43], v[48:51], v[92:95]
    ds_read_b128 v[28:31], v13 offset:1024
    v_mfma_f32_16x16x32_bf16 v[96:99], v[36:39], v[52:55], v[96:99]
    ds_read_b128 v[32:35], v13 offset:2048
    v_mfma_f32_16x16x32_bf16 v[100:103], v[40:43], v[52:55], v[100:103]
    s_add_u32 s77, s76, 8192
    buffer_load_dwordx4 a[32:35], v2, s[20:23], s77 offen offset:0
    buffer_load_dwordx4 a[36:39], v2, s[20:23], s77 offen offset:1024
    s_waitcnt lgkmcnt(5)
    v_mfma_f32_16x16x32_bf16 v[80:83], v[56:59], v[64:67], v[80:83]
    ds_read_b128 v[36:39], v8 offset:7168
    v_mfma_f32_16x16x32_bf16 v[84:87], v[60:63], v[64:67], v[84:87]
    ds_read_b128 v[40:43], v8 offset:19456
    v_mfma_f32_16x16x32_bf16 v[88:91], v[56:59], v[68:71], v[88:91]
    ds_read_b128 v[44:47], v13 offset:6144
    v_mfma_f32_16x16x32_bf16 v[92:95], v[60:63], v[68:71], v[92:95]
    ds_read_b128 v[48:51], v13 offset:7168
    v_mfma_f32_16x16x32_bf16 v[96:99], v[56:59], v[72:75], v[96:99]
    ds_read_b128 v[52:55], v13 offset:8192
    v_mfma_f32_16x16x32_bf16 v[100:103], v[60:63], v[72:75], v[100:103]
    buffer_load_dwordx4 a[40:43], v2, s[20:23], s77 offen offset:2048
    buffer_load_dwordx4 a[44:47], v2, s[20:23], s77 offen offset:3072
    s_waitcnt vmcnt(12)
    s_barrier
    s_cmp_lg_u32 s3, 3
    s_cbranch_scc1 LN_nofr1
    v_mov_b32 v5, 1
    s_mov_b64 exec, s[98:99]
    buffer_store_dword v5, v124, s[20:23], 0 offen sc1
    s_mov_b64 exec, -1
LN_nofr1:
    s_waitcnt lgkmcnt(5)
    v_mfma_f32_16x16x32_bf16 v[80:83], v[16:19], v[24:27], v[80:83]
    ds_read_b128 v[56:59], v8 offset:8192
    v_mfma_f32_16x16x32_bf16 v[84:87], v[20:23], v[24:27], v[84:87]
    ds_read_b128 v[60:63], v8 offset:20480
    v_mfma_f32_16x16x32_bf16 v[88:91], v[16:19], v[28:31], v[88:91]
    ds_read_b128 v[64:67], v13 offset:12288
    v_mfma_f32_16x16x32_bf16 v[92:95], v[20:23], v[28:31], v[92:95]
    ds_read_b128 v[68:71], v13 offset:13312
    v_mfma_f32_16x16x32_bf16 v[96:99], v[16:19], v[32:35], v[96:99]
    ds_read_b128 v[72:75], v13 offset:14336
    v_mfma_f32_16x16x32_bf16 v[100:103], v[20:23], v[32:35], v[100:103]
    s_add_u32 s77, s76, 12288
    buffer_load_dwordx4 a[48:51], v2, s[20:23], s77 offen offset:0
    buffer_load_dwordx4 a[52:55], v2, s[20:23], s77 offen offset:1024
    s_waitcnt lgkmcnt(5)
    v_mfma_f32_16x16x32_bf16 v[80:83], v[36:39], v[44:47], v[80:83]
    ds_read_b128 v[16:19], v8 offset:9216
    v_mfma_f32_16x16x32_bf16 v[84:87], v[40:43], v[44:47], v[84:87]
    ds_read_b128 v[20:23], v8 offset:21504
    v_mfma_f32_16x16x32_bf16 v[88:91], v[36:39], v[48:51], v[88:91]
    ds_read_b128 v[24:27], v13 offset:18432
    v_mfma_f32_16x16x32_bf16 v[92:95], v[40:43], v[48:51], v[92:95]
    ds_read_b128 v[28:31], v13 offset:19456
    v_mfma_f32_16x16x32_bf16 v[96:99], v[36:39], v[52:55], v[96:99]
    ds_read_b128 v[32:35], v13 offset:20480
    v_mfma_f32_16x16x32_bf16 v[100:103], v[40:43], v[52:55], v[100:103]
    buffer_load_dwordx4 a[56:59], v2, s[20:23], s77 offen offset:2048
    buffer_load_dwordx4 a[60:63], v2, s[20:23], s77 offen offset:3072
    s_waitcnt lgkmcnt(5)
    v_mfma_f32_16x16x32_bf16 v[80:83], v[56:59], v[64:67], v[80:83]
    ds_read_b128 v[36:39], v8 offset:10240
    v_mfma_f32_16x16x32_bf16 v[84:87], v[60:63], v[64:67], v[84:87]
    ds_read_b128 v[40:43], v8 offset:22528
    v_mfma_f32_16x16x32_bf16 v[88:91], v[56:59], v[68:71], v[88:91]
    ds_read_b128 v[44:47], v13 offset:24576
    v_mfma_f32_16x16x32_bf16 v[92:95], v[60:63], v[68:71], v[92:95]
    ds_read_b128 v[48:51], v13 offset:25600
    v_mfma_f32_16x16x32_bf16 v[96:99], v[56:59], v[72:75], v[96:99]
    ds_read_b128 v[52:55], v13 offset:26624
    v_mfma_f32_16x16x32_bf16 v[100:103], v[60:63], v[72:75], v[100:103]
    s_add_u32 s77, s76, 16384
    buffer_load_dwordx4 a[64:67], v2, s[20:23], s77 offen offset:0
    buffer_load_dwordx4 a[68:71], v2, s[20:23], s77 offen offset:1024
    s_waitcnt lgkmcnt(5)
    v_mfma_f32_16x16x32_bf16 v[80:83], v[16:19], v[24:27], v[80:83]
    ds_read_b128 v[56:59], v8 offset:11264
    v_mfma_f32_16x16x32_bf16 v[84:87], v[20:23], v[24:27], v[84:87]
    ds_read_b128 v[60:63], v8 offset:23552
    v_mfma_f32_16x16x32_bf16 v[88:91], v[16:19], v[28:31], v[88:91]
    ds_read_b128 v[64:67], v13 offset:30720
    v_mfma_f32_16x16x32_bf16 v[92:95], v[20:23], v[28:31], v[92:95]
    ds_read_b128 v[68:71], v13 offset:31744
    v_mfma_f32_16x16x32_bf16 v[96:99], v[16:19], v[32:35], v[96:99]
    ds_read_b128 v[72:75], v13 offset:32768
    v_mfma_f32_16x16x32_bf16 v[100:103], v[20:23], v[32:35], v[100:103]
    buffer_load_dwordx4 a[72:75], v2, s[20:23], s77 offen offset:2048
    buffer_load_dwordx4 a[76:79], v2, s[20:23], s77 offen offset:3072
    s_waitcnt lgkmcnt(5)
    v_mfma_f32_16x16x32_bf16 v[80:83], v[36:39], v[44:47], v[80:83]
    v_mfma_f32_16x16x32_bf16 v[84:87], v[40:43], v[44:47], v[84:87]
    v_mfma_f32_16x16x32_bf16 v[88:91], v[36:39], v[48:51], v[88:91]
    v_mfma_f32_16x16x32_bf16 v[92:95], v[40:43], v[48:51], v[92:95]
    v_mfma_f32_16x16x32_bf16 v[96:99], v[36:39], v[52:55], v[96:99]
    v_mfma_f32_16x16x32_bf16 v[100:103], v[40:43], v[52:55], v[100:103]
    s_add_u32 s77, s76, 20480
    buffer_load_dwordx4 a[80:83], v2, s[20:23], s77 offen offset:0
    buffer_load_dwordx4 a[84:87], v2, s[20:23], s77 offen offset:1024
    s_waitcnt lgkmcnt(0)
    v_mfma_f32_16x16x32_bf16 v[80:83], v[56:59], v[64:67], v[80:83]
    v_mfma_f32_16x16x32_bf16 v[84:87], v[60:63], v[64:67], v[84:87]
    v_mfma_f32_16x16x32_bf16 v[88:91], v[56:59], v[68:71], v[88:91]
    v_mfma_f32_16x16x32_bf16 v[92:95], v[60:63], v[68:71], v[92:95]
    v_mfma_f32_16x16x32_bf16 v[96:99], v[56:59], v[72:75], v[96:99]
    v_mfma_f32_16x16x32_bf16 v[100:103], v[60:63], v[72:75], v[100:103]
    buffer_load_dwordx4 a[88:91], v2, s[20:23], s77 offen offset:2048
    buffer_load_dwordx4 a[92:95], v2, s[20:23], s77 offen offset:3072
    s_nop 0
    v_cvt_pk_bf16_f32 v80, v80, v81
    v_cvt_pk_bf16_f32 v81, v82, v83
    v_cvt_pk_bf16_f32 v82, v84, v85
    v_cvt_pk_bf16_f32 v83, v86, v87
    s_add_u32 s31, s65, 0
    buffer_store_dwordx4 v[80:83], v2, s[20:23], s31 offen sc1
    v_cvt_pk_bf16_f32 v88, v88, v89
    v_cvt_pk_bf16_f32 v89, v90, v91
    v_cvt_pk_bf16_f32 v90, v92, v93
    v_cvt_pk_bf16_f32 v91, v94, v95
    s_add_u32 s31, s65, 32768
    buffer_store_dwordx4 v[88:91], v2, s[20:23], s31 offen sc1
    v_cvt_pk_bf16_f32 v96, v96, v97
    v_cvt_pk_bf16_f32 v97, v98, v99
    v_cvt_pk_bf16_f32 v98, v100, v101
    v_cvt_pk_bf16_f32 v99, v102, v103
    s_add_u32 s31, s65, 65536
    buffer_store_dwordx4 v[96:99], v2, s[20:23], s31 offen sc1
LN_g_done:
    v_mov_b32 v4, s64
    v_mov_b32 v5, 1
    s_mov_b64 exec, 1
    buffer_store_dword v5, v4, s[20:23], 0 offen sc1
    s_mov_b64 exec, -1
LN_g_done2:
    s_mul_i32 s84, s27, 49152
    s_mul_i32 s85, s3, 6144
    s_add_u32 s84, s84, s85
    s_add_u32 s84, s84, 4194304
    s_add_u32 s85, s85, 0
    s_mul_i32 s87, s3, 24576
    s_add_u32 s86, s89, s87
    s_add_u32 s87, s87, 51200
    s_lshl_b32 s29, s24, 3
    s_add_u32 s29, s29, s26
    s_lshl_b32 s29, s29, 8
    s_add_u32 s29, s29, 7409664
    v_min_u32 v12, 47, v1
    v_lshl_add_u32 v12, v12, 2, s29
    s_lshl_b32 s29, s27, 7
    s_add_u32 s29, s29, 7405568
    v_lshl_add_u32 v11, v1, 2, s29
    v_and_b32 v10, 7, v1
    v_lshl_add_u32 v10, v10, 2, s100
    v_cmp_gt_u32 vcc, 16, v1
    s_nop 1
    v_cndmask_b32 v11, v10, v11, vcc
    s_cmp_lg_u32 s3, 3
    s_cbranch_scc1 LN_w1_done
    s_mov_b32 s68, 524288
    s_mov_b64 exec, 0xffffff
    s_branch LN_w1_first
LN_w1_loop:
    s_sleep 1
LN_w1_first:
    buffer_load_dword v4, v11, s[20:23], 0 offen sc1
    s_sub_u32 s68, s68, 1
    s_waitcnt vmcnt(0)
    v_cmp_eq_u32 vcc, 0, v4
    s_cmp_eq_u32 s68, 0
    s_cbranch_scc1 LN_w1_out
    s_nop 2
    s_cbranch_vccnz LN_w1_loop
LN_w1_out:
    s_mov_b64 exec, -1
LN_w1_done:
LN_s_retry:
    s_barrier
    s_add_u32 m0, s85, 0
    s_add_u32 s32, s84, 0
    buffer_load_dwordx4 v2, s[20:23], s32 offen offset:0 sc1 lds
    buffer_load_dwordx4 v2, s[20:23], s32 offen offset:1024 sc1 lds
    buffer_load_dwordx4 v2, s[20:23], s32 offen offset:2048 sc1 lds
    buffer_load_dwordx4 v2, s[20:23], s32 offen offset:3072 sc1 lds
    s_add_u32 m0, s85, 4096
    s_add_u32 s32, s84, 4096
    buffer_load_dwordx4 v2, s[20:23], s32 offen offset:0 sc1 lds
    buffer_load_dwordx4 v2, s[20:23], s32 offen offset:1024 sc1 lds
    s_add_u32 m0, s85, 24576
    s_add_u32 s32, s84, 24576
    buffer_load_dwordx4 v2, s[20:23], s32 offen offset:0 sc1 lds
    buffer_load_dwordx4 v2, s[20:23], s32 offen offset:1024 sc1 lds
    buffer_load_dwordx4 v2, s[20:23], s32 offen offset:2048 sc1 lds
    buffer_load_dwordx4 v2, s[20:23], s32 offen offset:3072 sc1 lds
    s_add_u32 m0, s85, 28672
    s_add_u32 s32, s84, 28672
    buffer_load_dwordx4 v2, s[20:23], s32 offen offset:0 sc1 lds
    buffer_load_dwordx4 v2, s[20:23], s32 offen offset:1024 sc1 lds
    buffer_load_dword v3, v12, s[20:23], 0 offen sc1
    s_waitcnt vmcnt(7)
    s_barrier
    ds_read_b128 v[48:51], v2 offset:0
    ds_read_b128 v[52:55], v2 offset:1024
    ds_read_b128 v[56:59], v2 offset:2048
    s_waitcnt lgkmcnt(2)
    v_mfma_f32_32x32x16_bf16 v[16:31], a[0:3], v[48:51], 0
    ds_read_b128 v[60:63], v2 offset:3072
    s_waitcnt lgkmcnt(2)
    v_mfma_f32_32x32x16_bf16 v[16:31], a[4:7], v[52:55], v[16:31]
    ds_read_b128 v[48:51], v2 offset:4096
    s_waitcnt lgkmcnt(2)
    v_mfma_f32_32x32x16_bf16 v[16:31], a[8:11], v[56:59], v[16:31]
    ds_read_b128 v[52:55], v2 offset:5120
    s_waitcnt lgkmcnt(2)
    v_mfma_f32_32x32x16_bf16 v[16:31], a[12:15], v[60:63], v[16:31]
    ds_read_b128 v[56:59], v2 offset:6144
    s_waitcnt lgkmcnt(2)
    v_mfma_f32_32x32x16_bf16 v[16:31], a[16:19], v[48:51], v[16:31]
    ds_read_b128 v[60:63], v2 offset:7168
    s_waitcnt lgkmcnt(2)
    v_mfma_f32_32x32x16_bf16 v[16:31], a[20:23], v[52:55], v[16:31]
    ds_read_b128 v[48:51], v2 offset:8192
    s_waitcnt lgkmcnt(2)
    v_mfma_f32_32x32x16_bf16 v[16:31], a[24:27], v[56:59], v[16:31]
    ds_read_b128 v[52:55], v2 offset:9216
    s_waitcnt lgkmcnt(2)
    v_mfma_f32_32x32x16_bf16 v[16:31], a[28:31], v[60:63], v[16:31]
    ds_read_b128 v[56:59], v2 offset:10240
    s_waitcnt lgkmcnt(2)
    v_mfma_f32_32x32x16_bf16 v[16:31], a[32:35], v[48:51], v[16:31]
    ds_read_b128 v[60:63], v2 offset:11264
    s_waitcnt lgkmcnt(2)
    v_mfma_f32_32x32x16_bf16 v[16:31], a[36:39], v[52:55], v[16:31]
    ds_read_b128 v[48:51], v2 offset:12288
    s_waitcnt lgkmcnt(2)
    v_mfma_f32_32x32x16_bf16 v[16:31], a[40:43], v[56:59], v[16:31]
    ds_read_b128 v[52:55], v2 offset:13312
    s_waitcnt lgkmcnt(2)
    v_mfma_f32_32x32x16_bf16 v[16:31], a[44:47], v[60:63], v[16:31]
    ds_read_b128 v[56:59], v2 offset:14336
    s_waitcnt lgkmcnt(2)
    v_mfma_f32_32x32x16_bf16 v[16:31], a[48:51], v[48:51], v[16:31]
    ds_read_b128 v[60:63], v2 offset:15360
    s_waitcnt lgkmcnt(2)
    v_mfma_f32_32x32x16_bf16 v[16:31], a[52:55], v[52:55], v[16:31]
    ds_read_b128 v[48:51], v2 offset:16384
    s_waitcnt lgkmcnt(2)
    v_mfma_f32_32x32x16_bf16 v[16:31], a[56:59], v[56:59], v[16:31]
    ds_read_b128 v[52:55], v2 offset:17408
    s_waitcnt lgkmcnt(2)
    v_mfma_f32_32x32x16_bf16 v[16:31], a[60:63], v[60:63], v[16:31]
    ds_read_b128 v[56:59], v2 offset:18432
    s_waitcnt lgkmcnt(2)
    v_mfma_f32_32x32x16_bf16 v[16:31], a[64:67], v[48:51], v[16:31]
    ds_read_b128 v[60:63], v2 offset:19456
    s_waitcnt lgkmcnt(2)
    v_mfma_f32_32x32x16_bf16 v[16:31], a[68:71], v[52:55], v[16:31]
    ds_read_b128 v[48:51], v2 offset:20480
    s_waitcnt lgkmcnt(2)
    v_mfma_f32_32x32x16_bf16 v[16:31], a[72:75], v[56:59], v[16:31]
    ds_read_b128 v[52:55], v2 offset:21504
    s_waitcnt lgkmcnt(2)
    v_mfma_f32_32x32x16_bf16 v[16:31], a[76:79], v[60:63], v[16:31]
    ds_read_b128 v[56:59], v2 offset:22528
    s_waitcnt lgkmcnt(2)
    v_mfma_f32_32x32x16_bf16 v[16:31], a[80:83], v[48:51], v[16:31]
    ds_read_b128 v[60:63], v2 offset:23552
    s_waitcnt vmcnt(0)
    v_cmp_eq_u32 vcc, 0, v3
    s_barrier
    s_nop 0
    s_cmp_lg_u64 vcc, 0
    s_cselect_b32 s88, 1, 0
    s_waitcnt lgkmcnt(2)
    v_mfma_f32_32x32x16_bf16 v[16:31], a[84:87], v[52:55], v[16:31]
    ds_read_b128 v[48:51], v2 offset:24576
    s_cmp_eq_u32 s88, 1
    s_cbranch_scc1 LN_vskip0
    s_add_u32 m0, s87, 0
    s_add_u32 s32, s86, 0
    buffer_load_dwordx4 v2, s[20:23], s32 offen offset:0 sc1 lds
    buffer_load_dwordx4 v2, s[20:23], s32 offen offset:1024 sc1 lds
    buffer_load_dwordx4 v2, s[20:23], s32 offen offset:2048 sc1 lds
    buffer_load_dwordx4 v2, s[20:23], s32 offen offset:3072 sc1 lds
LN_vskip0:
    s_waitcnt lgkmcnt(2)
    v_mfma_f32_32x32x16_bf16 v[16:31], a[88:91], v[56:59], v[16:31]
    ds_read_b128 v[52:55], v2 offset:25600
    s_waitcnt lgkmcnt(2)
    v_mfma_f32_32x32x16_bf16 v[16:31], a[92:95], v[60:63], v[16:31]
    ds_read_b128 v[56:59], v2 offset:26624
    s_waitcnt lgkmcnt(2)
    v_mfma_f32_32x32x16_bf16 v[32:47], a[0:3], v[48:51], 0
    ds_read_b128 v[60:63], v2 offset:27648
    s_waitcnt lgkmcnt(2)
    v_mfma_f32_32x32x16_bf16 v[32:47], a[4:7], v[52:55], v[32:47]
    ds_read_b128 v[48:51], v2 offset:28672
    s_waitcnt lgkmcnt(2)
    v_mfma_f32_32x32x16_bf16 v[32:47], a[8:11], v[56:59], v[32:47]
    ds_read_b128 v[52:55], v2 offset:29696
    s_nop 1
    v_max3_f32 v72, v16, v17, v18
    v_max3_f32 v73, v19, v20, v21
    v_max3_f32 v74, v22, v23, v24
    s_waitcnt lgkmcnt(2)
    v_mfma_f32_32x32x16_bf16 v[32:47], a[12:15], v[60:63], v[32:47]
    ds_read_b128 v[56:59], v2 offset:30720
    v_max3_f32 v75, v25, v26, v27
    v_max3_f32 v76, v28, v29, v30
    v_max3_f32 v72, v72, v73, v74
    s_cmp_eq_u32 s88, 1
    s_cbranch_scc1 LN_vskip1
    s_add_u32 m0, s87, 4096
    s_add_u32 s32, s86, 4096
    buffer_load_dwordx4 v2, s[20:23], s32 offen offset:0 sc1 lds
    buffer_load_dwordx4 v2, s[20:23], s32 offen offset:1024 sc1 lds
    buffer_load_dwordx4 v2, s[20:23], s32 offen offset:2048 sc1 lds
    buffer_load_dwordx4 v2, s[20:23], s32 offen offset:3072 sc1 lds
LN_vskip1:
    s_waitcnt lgkmcnt(2)
    v_mfma_f32_32x32x16_bf16 v[32:47], a[16:19], v[48:51], v[32:47]
    ds_read_b128 v[60:63], v2 offset:31744
    v_max3_f32 v75, v75, v76, v31
    v_max_f32 v64, v72, v75
    v_mov_b32 v68, v64
    s_waitcnt lgkmcnt(2)
    v_mfma_f32_32x32x16_bf16 v[32:47], a[20:23], v[52:55], v[32:47]
    ds_read_b128 v[48:51], v2 offset:32768
    v_permlane32_swap_b32 v68, v64
    v_max_f32 v64, v64, v68
    v_pk_add_f32 v[16:17], v[16:17], v[64:65] op_sel:[0,0] op_sel_hi:[1,0] neg_lo:[0,1] neg_hi:[0,1]
    s_waitcnt lgkmcnt(2)
    v_mfma_f32_32x32x16_bf16 v[32:47], a[24:27], v[56:59], v[32:47]
    ds_read_b128 v[52:55], v2 offset:33792
    v_pk_add_f32 v[18:19], v[18:19], v[64:65] op_sel:[0,0] op_sel_hi:[1,0] neg_lo:[0,1] neg_hi:[0,1]
    v_pk_add_f32 v[20:21], v[20:21], v[64:65] op_sel:[0,0] op_sel_hi:[1,0] neg_lo:[0,1] neg_hi:[0,1]
    v_pk_add_f32 v[22:23], v[22:23], v[64:65] op_sel:[0,0] op_sel_hi:[1,0] neg_lo:[0,1] neg_hi:[0,1]
    s_waitcnt lgkmcnt(2)
    v_mfma_f32_32x32x16_bf16 v[32:47], a[28:31], v[60:63], v[32:47]
    ds_read_b128 v[56:59], v2 offset:34816
    v_pk_add_f32 v[24:25], v[24:25], v[64:65] op_sel:[0,0] op_sel_hi:[1,0] neg_lo:[0,1] neg_hi:[0,1]
    v_pk_add_f32 v[26:27], v[26:27], v[64:65] op_sel:[0,0] op_sel_hi:[1,0] neg_lo:[0,1] neg_hi:[0,1]
    v_pk_add_f32 v[28:29], v[28:29], v[64:65] op_sel:[0,0] op_sel_hi:[1,0] neg_lo:[0,1] neg_hi:[0,1]
    s_waitcnt lgkmcnt(2)
    v_mfma_f32_32x32x16_bf16 v[32:47], a[32:35], v[48:51], v[32:47]
    ds_read_b128 v[60:63], v2 offset:35840
    v_pk_add_f32 v[30:31], v[30:31], v[64:65] op_sel:[0,0] op_sel_hi:[1,0] neg_lo:[0,1] neg_hi:[0,1]
    v_exp_f32 v16, v16
    v_exp_f32 v17, v17
    s_waitcnt lgkmcnt(2)
    v_mfma_f32_32x32x16_bf16 v[32:47], a[36:39], v[52:55], v[32:47]
    ds_read_b128 v[48:51], v2 offset:36864
    v_exp_f32 v18, v18
    v_exp_f32 v19, v19
    v_exp_f32 v20, v20
    s_cmp_eq_u32 s88, 1
    s_cbranch_scc1 LN_vskip2
    s_add_u32 m0, s87, 8192
    s_add_u32 s32, s86, 8192
    buffer_load_dwordx4 v2, s[20:23], s32 offen offset:0 sc1 lds
    buffer_load_dwordx4 v2, s[20:23], s32 offen offset:1024 sc1 lds
    buffer_load_dwordx4 v2, s[20:23], s32 offen offset:2048 sc1 lds
    buffer_load_dwordx4 v2, s[20:23], s32 offen offset:3072 sc1 lds
LN_vskip2:
    s_waitcnt lgkmcnt(2)
    v_mfma_f32_32x32x16_bf16 v[32:47], a[40:43], v[56:59], v[32:47]
    ds_read_b128 v[52:55], v2 offset:37888
    v_exp_f32 v21, v21
    v_exp_f32 v22, v22
    v_exp_f32 v23, v23
    s_waitcnt lgkmcnt(2)
    v_mfma_f32_32x32x16_bf16 v[32:47], a[44:47], v[60:63], v[32:47]
    ds_read_b128 v[56:59], v2 offset:38912
    v_exp_f32 v24, v24
    v_exp_f32 v25, v25
    v_exp_f32 v26, v26
    s_waitcnt lgkmcnt(2)
    v_mfma_f32_32x32x16_bf16 v[32:47], a[48:51], v[48:51], v[32:47]
    ds_read_b128 v[60:63], v2 offset:39936
    v_exp_f32 v27, v27
    v_exp_f32 v28, v28
    v_exp_f32 v29, v29
    s_waitcnt lgkmcnt(2)
    v_mfma_f32_32x32x16_bf16 v[32:47], a[52:55], v[52:55], v[32:47]
    ds_read_b128 v[48:51], v2 offset:40960
    v_exp_f32 v30, v30
    v_exp_f32 v31, v31
    v_pk_add_f32 v[72:73], v[16:17], v[18:19]
    s_waitcnt lgkmcnt(2)
    v_mfma_f32_32x32x16_bf16 v[32:47], a[56:59], v[56:59], v[32:47]
    ds_read_b128 v[52:55], v2 offset:41984
    v_pk_add_f32 v[74:75], v[20:21], v[22:23]
    v_pk_add_f32 v[76:77], v[24:25], v[26:27]
    v_pk_add_f32 v[78:79], v[28:29], v[30:31]
    s_waitcnt lgkmcnt(2)
    v_mfma_f32_32x32x16_bf16 v[32:47], a[60:63], v[60:63], v[32:47]
    ds_read_b128 v[56:59], v2 offset:43008
    v_pk_add_f32 v[72:73], v[72:73], v[74:75]
    v_pk_add_f32 v[76:77], v[76:77], v[78:79]
    v_pk_add_f32 v[72:73], v[72:73], v[76:77]
    s_cmp_eq_u32 s88, 1
    s_cbranch_scc1 LN_vskip3
    s_add_u32 m0, s87, 12288
    s_add_u32 s32, s86, 12288
    buffer_load_dwordx4 v2, s[20:23], s32 offen offset:0 sc1 lds
    buffer_load_dwordx4 v2, s[20:23], s32 offen offset:1024 sc1 lds
    buffer_load_dwordx4 v2, s[20:23], s32 offen offset:2048 sc1 lds
    buffer_load_dwordx4 v2, s[20:23], s32 offen offset:3072 sc1 lds
LN_vskip3:
    s_waitcnt lgkmcnt(2)
    v_mfma_f32_32x32x16_bf16 v[32:47], a[64:67], v[48:51], v[32:47]
    ds_read_b128 v[60:63], v2 offset:44032
    v_add_f32 v66, v72, v73
    v_mov_b32 v68, v66
    s_nop 1
    v_permlane32_swap_b32 v68, v66
    s_waitcnt lgkmcnt(2)
    v_mfma_f32_32x32x16_bf16 v[32:47], a[68:71], v[52:55], v[32:47]
    ds_read_b128 v[48:51], v2 offset:45056
    v_add_f32 v66, v66, v68
    s_waitcnt lgkmcnt(2)
    v_mfma_f32_32x32x16_bf16 v[32:47], a[72:75], v[56:59], v[32:47]
    ds_read_b128 v[52:55], v2 offset:46080
    s_waitcnt lgkmcnt(2)
    v_mfma_f32_32x32x16_bf16 v[32:47], a[76:79], v[60:63], v[32:47]
    ds_read_b128 v[56:59], v2 offset:47104
    s_waitcnt lgkmcnt(2)
    v_mfma_f32_32x32x16_bf16 v[32:47], a[80:83], v[48:51], v[32:47]
    ds_read_b128 v[60:63], v2 offset:48128
    s_waitcnt lgkmcnt(2)
    v_mfma_f32_32x32x16_bf16 v[32:47], a[84:87], v[52:55], v[32:47]
    s_cmp_eq_u32 s88, 1
    s_cbranch_scc1 LN_vskip4
    s_add_u32 m0, s87, 16384
    s_add_u32 s32, s86, 16384
    buffer_load_dwordx4 v2, s[20:23], s32 offen offset:0 sc1 lds
    buffer_load_dwordx4 v2, s[20:23], s32 offen offset:1024 sc1 lds
    buffer_load_dwordx4 v2, s[20:23], s32 offen offset:2048 sc1 lds
    buffer_load_dwordx4 v2, s[20:23], s32 offen offset:3072 sc1 lds
LN_vskip4:
    s_waitcnt lgkmcnt(1)
    v_mfma_f32_32x32x16_bf16 v[32:47], a[88:91], v[56:59], v[32:47]
    s_waitcnt lgkmcnt(0)
    v_mfma_f32_32x32x16_bf16 v[32:47], a[92:95], v[60:63], v[32:47]
    s_nop 11
    v_max3_f32 v80, v32, v33, v34
    v_max3_f32 v81, v35, v36, v37
    v_max3_f32 v82, v38, v39, v40
    v_max3_f32 v83, v41, v42, v43
    v_max3_f32 v84, v44, v45, v46
    v_max3_f32 v80, v80, v81, v82
    v_max3_f32 v83, v83, v84, v47
    v_max_f32 v65, v80, v83
    v_mov_b32 v69, v65
    s_nop 1
    v_permlane32_swap_b32 v69, v65
    v_max_f32 v65, v65, v69
    v_pk_add_f32 v[32:33], v[32:33], v[64:65] op_sel:[0,1] op_sel_hi:[1,1] neg_lo:[0,1] neg_hi:[0,1]
    v_pk_add_f32 v[34:35], v[34:35], v[64:65] op_sel:[0,1] op_sel_hi:[1,1] neg_lo:[0,1] neg_hi:[0,1]
    v_pk_add_f32 v[36:37], v[36:37], v[64:65] op_sel:[0,1] op_sel_hi:[1,1] neg_lo:[0,1] neg_hi:[0,1]
    v_pk_add_f32 v[38:39], v[38:39], v[64:65] op_sel:[0,1] op_sel_hi:[1,1] neg_lo:[0,1] neg_hi:[0,1]
    v_pk_add_f32 v[40:41], v[40:41], v[64:65] op_sel:[0,1] op_sel_hi:[1,1] neg_lo:[0,1] neg_hi:[0,1]
    v_pk_add_f32 v[42:43], v[42:43], v[64:65] op_sel:[0,1] op_sel_hi:[1,1] neg_lo:[0,1] neg_hi:[0,1]
    v_pk_add_f32 v[44:45], v[44:45], v[64:65] op_sel:[0,1] op_sel_hi:[1,1] neg_lo:[0,1] neg_hi:[0,1]
    v_pk_add_f32 v[46:47], v[46:47], v[64:65] op_sel:[0,1] op_sel_hi:[1,1] neg_lo:[0,1] neg_hi:[0,1]
    v_exp_f32 v32, v32
    v_exp_f32 v33, v33
    v_exp_f32 v34, v34
    v_exp_f32 v35, v35
    v_exp_f32 v36, v36
    v_exp_f32 v37, v37
    s_cmp_eq_u32 s88, 1
    s_cbranch_scc1 LN_vskip5
    s_add_u32 m0, s87, 20480
    s_add_u32 s32, s86, 20480
    buffer_load_dwordx4 v2, s[20:23], s32 offen offset:0 sc1 lds
    buffer_load_dwordx4 v2, s[20:23], s32 offen offset:1024 sc1 lds
    buffer_load_dwordx4 v2, s[20:23], s32 offen offset:2048 sc1 lds
    buffer_load_dwordx4 v2, s[20:23], s32 offen offset:3072 sc1 lds
LN_vskip5:
    v_exp_f32 v38, v38
    v_exp_f32 v39, v39
    v_exp_f32 v40, v40
    v_exp_f32 v41, v41
    v_exp_f32 v42, v42
    v_exp_f32 v43, v43
    v_exp_f32 v44, v44
    v_exp_f32 v45, v45
    v_exp_f32 v46, v46
    v_exp_f32 v47, v47
    v_pk_add_f32 v[80:81], v[32:33], v[34:35]
    v_pk_add_f32 v[82:83], v[36:37], v[38:39]
    v_pk_add_f32 v[84:85], v[40:41], v[42:43]
    v_pk_add_f32 v[86:87], v[44:45], v[46:47]
    v_pk_add_f32 v[80:81], v[80:81], v[82:83]
    v_pk_add_f32 v[84:85], v[84:85], v[86:87]
    v_pk_add_f32 v[80:81], v[80:81], v[84:85]
    v_add_f32 v67, v80, v81
    v_mov_b32 v69, v67
    s_nop 1
    v_permlane32_swap_b32 v69, v67
    v_add_f32 v67, v67, v69
    v_cmp_gt_u32 s[92:93], 32, v1
    v_lshlrev_b32 v3, 3, v1
    s_lshl_b32 s29, s3, 9
    v_add_u32 v4, s29, v3
    v_cndmask_b32 v70, v65, v64, s[92:93]
    v_cndmask_b32 v71, v67, v66, s[92:93]
    ds_write_b64 v4, v[70:71] offset:49152
    v_and_b32 v5, 31, v1
    v_lshlrev_b32 v5, 3, v5
    s_waitcnt lgkmcnt(0)
    s_barrier
    ds_read_b64 v[72:73], v5 offset:49152
    ds_read_b64 v[74:75], v5 offset:49664
    ds_read_b64 v[76:77], v5 offset:50176
    ds_read_b64 v[78:79], v5 offset:50688
    ds_read_b64 v[80:81], v5 offset:49408
    ds_read_b64 v[82:83], v5 offset:49920
    ds_read_b64 v[84:85], v5 offset:50432
    ds_read_b64 v[86:87], v5 offset:50944
    v_bfe_u32 v9, v1, 4, 1
    v_lshlrev_b32 v9, 15, v9
    v_lshrrev_b32 v10, 5, v1
    v_lshl_add_u32 v9, v10, 8, v9
    v_lshl_add_u32 v9, v6, 4, v9
    s_lshl_b32 s29, s27, 7
    s_add_u32 s101, s29, 7413760
    s_lshl_b32 s30, s26, 4
    s_add_u32 s64, s101, s30
    s_lshl_b32 s30, s3, 2
    s_add_u32 s64, s64, s30
    s_waitcnt lgkmcnt(0)
    v_max3_f32 v88, v72, v74, v76
    v_max3_f32 v89, v80, v82, v84
    v_max_f32 v88, v88, v78
    v_max_f32 v89, v89, v86
    v_sub_f32 v72, v72, v88
    v_sub_f32 v76, v76, v88
    v_sub_f32 v80, v80, v89
    v_sub_f32 v84, v84, v89
    v_sub_f32 v74, v74, v88
    v_sub_f32 v78, v78, v88
    v_exp_f32 v72, v72
    v_exp_f32 v76, v76
    v_sub_f32 v82, v82, v89
    v_sub_f32 v86, v86, v89
    v_exp_f32 v80, v80
    v_exp_f32 v84, v84
    v_exp_f32 v74, v74
    v_exp_f32 v78, v78
    v_mul_f32 v90, v72, v73
    v_mul_f32 v94, v76, v77
    v_exp_f32 v82, v82
    v_exp_f32 v86, v86
    v_mul_f32 v91, v80, v81
    v_mul_f32 v95, v84, v85
    v_sub_f32 v92, v64, v88
    v_fmac_f32 v90, v74, v75
    v_fmac_f32 v94, v78, v79
    v_sub_f32 v93, v65, v89
    v_fmac_f32 v91, v82, v83
    v_fmac_f32 v95, v86, v87
    v_exp_f32 v92, v92
    v_add_f32 v90, v90, v94
    v_exp_f32 v93, v93
    v_add_f32 v91, v91, v95
    v_cmp_u_f32 vcc, v90, v91
    v_rcp_f32 v94, v90
    v_rcp_f32 v95, v91
    v_log_f32 v90, v90
    v_log_f32 v91, v91
    s_cbranch_vccnz LN_s_retry0
LN_s_cont:
    v_mul_f32 v92, v92, v94
    v_mul_f32 v93, v93, v95
    v_add_f32 v88, v88, v90
    v_add_f32 v89, v89, v91
    s_cmp_lg_u32 s3, 0
    s_cbranch_scc1 LN_noml
    v_cndmask_b32 v10, v89, v88, s[92:93]
    v_lshlrev_b32 v3, 5, v1
    s_lshl_b32 s31, s27, 11
    s_lshl_b32 s30, s26, 2
    s_add_u32 s31, s31, s30
    s_add_u32 s31, s31, 7340032
    buffer_store_dword v10, v3, s[20:23], s31 offen sc1
LN_noml:
    s_add_u32 s31, s96, 65536
    v_pk_mul_f32 v[16:17], v[16:17], v[92:93] op_sel:[0,0] op_sel_hi:[1,0]
    v_pk_mul_f32 v[18:19], v[18:19], v[92:93] op_sel:[0,0] op_sel_hi:[1,0]
    v_pk_mul_f32 v[24:25], v[24:25], v[92:93] op_sel:[0,0] op_sel_hi:[1,0]
    v_pk_mul_f32 v[26:27], v[26:27], v[92:93] op_sel:[0,0] op_sel_hi:[1,0]
    v_pk_mul_f32 v[20:21], v[20:21], v[92:93] op_sel:[0,0] op_sel_hi:[1,0]
    v_pk_mul_f32 v[22:23], v[22:23], v[92:93] op_sel:[0,0] op_sel_hi:[1,0]
    v_pk_mul_f32 v[28:29], v[28:29], v[92:93] op_sel:[0,0] op_sel_hi:[1,0]
    v_pk_mul_f32 v[30:31], v[30:31], v[92:93] op_sel:[0,0] op_sel_hi:[1,0]
    v_pk_mul_f32 v[32:33], v[32:33], v[92:93] op_sel:[0,1] op_sel_hi:[1,1]
    v_pk_mul_f32 v[34:35], v[34:35], v[92:93] op_sel:[0,1] op_sel_hi:[1,1]
    v_pk_mul_f32 v[40:41], v[40:41], v[92:93] op_sel:[0,1] op_sel_hi:[1,1]
    v_pk_mul_f32 v[42:43], v[42:43], v[92:93] op_sel:[0,1] op_sel_hi:[1,1]
    v_pk_mul_f32 v[36:37], v[36:37], v[92:93] op_sel:[0,1] op_sel_hi:[1,1]
    v_pk_mul_f32 v[38:39], v[38:39], v[92:93] op_sel:[0,1] op_sel_hi:[1,1]
    v_pk_mul_f32 v[44:45], v[44:45], v[92:93] op_sel:[0,1] op_sel_hi:[1,1]
    v_pk_mul_f32 v[46:47], v[46:47], v[92:93] op_sel:[0,1] op_sel_hi:[1,1]
    v_cvt_pk_bf16_f32 v96, v16, v17
    v_cvt_pk_bf16_f32 v97, v18, v19
    v_cvt_pk_bf16_f32 v98, v24, v25
    v_cvt_pk_bf16_f32 v99, v26, v27
    v_cvt_pk_bf16_f32 v100, v20, v21
    v_cvt_pk_bf16_f32 v101, v22, v23
    v_cvt_pk_bf16_f32 v102, v28, v29
    v_cvt_pk_bf16_f32 v103, v30, v31
    v_cvt_pk_bf16_f32 v104, v32, v33
    v_cvt_pk_bf16_f32 v105, v34, v35
    v_cvt_pk_bf16_f32 v106, v40, v41
    v_cvt_pk_bf16_f32 v107, v42, v43
    v_cvt_pk_bf16_f32 v108, v36, v37
    v_cvt_pk_bf16_f32 v109, v38, v39
    v_cvt_pk_bf16_f32 v110, v44, v45
    v_cvt_pk_bf16_f32 v111, v46, v47
    buffer_store_dwordx4 v[96:99], v9, s[20:23], s96 offen offset:0 sc1
    buffer_store_dwordx4 v[100:103], v9, s[20:23], s96 offen offset:512 sc1
    buffer_store_dwordx4 v[104:107], v9, s[20:23], s31 offen offset:0 sc1
    buffer_store_dwordx4 v[108:111], v9, s[20:23], s31 offen offset:512 sc1
    v_mov_b32 v4, s64
    v_mov_b32 v5, 1
    s_mov_b64 exec, 1
    buffer_store_dword v5, v4, s[20:23], 0 offen sc1
    s_mov_b64 exec, -1
    s_cmp_eq_u32 s88, 0
    s_cbranch_scc1 LN_v_ok
    s_mov_b32 s68, 524288
    s_mov_b64 exec, -1
    s_branch LN_w1v_first
LN_w1v_loop:
    s_sleep 1
LN_w1v_first:
    buffer_load_dword v4, v12, s[20:23], 0 offen sc1
    s_sub_u32 s68, s68, 1
    s_waitcnt vmcnt(0)
    v_cmp_eq_u32 vcc, 0, v4
    s_cmp_eq_u32 s68, 0
    s_cbranch_scc1 LN_w1v_out
    s_nop 2
    s_cbranch_vccnz LN_w1v_loop
LN_w1v_out:
    s_mov_b64 exec, -1
    s_add_u32 m0, s87, 0
    s_add_u32 s32, s86, 0
    buffer_load_dwordx4 v2, s[20:23], s32 offen offset:0 sc1 lds
    buffer_load_dwordx4 v2, s[20:23], s32 offen offset:1024 sc1 lds
    buffer_load_dwordx4 v2, s[20:23], s32 offen offset:2048 sc1 lds
    buffer_load_dwordx4 v2, s[20:23], s32 offen offset:3072 sc1 lds
    s_add_u32 m0, s87, 4096
    s_add_u32 s32, s86, 4096
    buffer_load_dwordx4 v2, s[20:23], s32 offen offset:0 sc1 lds
    buffer_load_dwordx4 v2, s[20:23], s32 offen offset:1024 sc1 lds
    buffer_load_dwordx4 v2, s[20:23], s32 offen offset:2048 sc1 lds
    buffer_load_dwordx4 v2, s[20:23], s32 offen offset:3072 sc1 lds
    s_add_u32 m0, s87, 8192
    s_add_u32 s32, s86, 8192
    buffer_load_dwordx4 v2, s[20:23], s32 offen offset:0 sc1 lds
    buffer_load_dwordx4 v2, s[20:23], s32 offen offset:1024 sc1 lds
    buffer_load_dwordx4 v2, s[20:23], s32 offen offset:2048 sc1 lds
    buffer_load_dwordx4 v2, s[20:23], s32 offen offset:3072 sc1 lds
    s_add_u32 m0, s87, 12288
    s_add_u32 s32, s86, 12288
    buffer_load_dwordx4 v2, s[20:23], s32 offen offset:0 sc1 lds
    buffer_load_dwordx4 v2, s[20:23], s32 offen offset:1024 sc1 lds
    buffer_load_dwordx4 v2, s[20:23], s32 offen offset:2048 sc1 lds
    buffer_load_dwordx4 v2, s[20:23], s32 offen offset:3072 sc1 lds
    s_add_u32 m0, s87, 16384
    s_add_u32 s32, s86, 16384
    buffer_load_dwordx4 v2, s[20:23], s32 offen offset:0 sc1 lds
    buffer_load_dwordx4 v2, s[20:23], s32 offen offset:1024 sc1 lds
    buffer_load_dwordx4 v2, s[20:23], s32 offen offset:2048 sc1 lds
    buffer_load_dwordx4 v2, s[20:23], s32 offen offset:3072 sc1 lds
    s_add_u32 m0, s87, 20480
    s_add_u32 s32, s86, 20480
    buffer_load_dwordx4 v2, s[20:23], s32 offen offset:0 sc1 lds
    buffer_load_dwordx4 v2, s[20:23], s32 offen offset:1024 sc1 lds
    buffer_load_dwordx4 v2, s[20:23], s32 offen offset:2048 sc1 lds
    buffer_load_dwordx4 v2, s[20:23], s32 offen offset:3072 sc1 lds
LN_v_ok:
    s_lshl_b32 s29, s27, 6
    s_lshl_b32 s30, s3, 4
    s_add_u32 s29, s29, s30
    v_add_u32 v12, s29, v6
    v_mul_u32_u24 v12, 768, v12
    v_lshl_add_u32 v12, v7, 3, v12
    s_mul_i32 s66, s26, 96
    v_lshlrev_b32 v13, 4, v7
    s_mul_i32 s29, s24, 1536
    s_mul_i32 s30, s26, 192
    s_add_u32 s29, s29, s30
    s_add_u32 s80, s29, 3158016
    v_lshlrev_b32 v3, 5, v6
    s_lshl_b32 s29, s27, 11
    s_lshl_b32 s30, s3, 9
    s_add_u32 s29, s29, s30
    s_add_u32 s92, s29, 7340032
    s_lshl_b32 s29, s3, 15
    s_add_u32 s93, s29, s97
    v_and_b32 v11, 31, v1
    v_lshl_add_u32 v11, v11, 2, s101
    s_add_u32 s29, s100, 0
    v_and_b32 v10, 7, v1
    v_lshl_add_u32 v10, v10, 2, s29
    v_cmp_gt_u32 vcc, 32, v1
    s_nop 1
    v_cndmask_b32 v11, v10, v11, vcc
    v_add_u32 v8, 51200, v2
    v_add_u32 v9, 116736, v2
    buffer_load_dwordx2 v[216:217], v12, s[44:47], s66 offen offset:0
    buffer_load_dwordx2 v[218:219], v12, s[44:47], s66 offen offset:32
    buffer_load_dwordx2 v[220:221], v12, s[44:47], s66 offen offset:64
    buffer_load_dwordx4 v[224:227], v13, s[20:23], s80 offen offset:0
    buffer_load_dwordx4 v[228:231], v13, s[20:23], s80 offen offset:64
    buffer_load_dwordx4 v[232:235], v13, s[20:23], s80 offen offset:128
    s_cmp_lg_u32 s3, 0
    s_cbranch_scc1 LN_w2_done
    s_mov_b32 s68, 524288
    s_mov_b64 exec, -1
    s_branch LN_w2_first
LN_w2_loop:
    s_sleep 1
LN_w2_first:
    buffer_load_dword v4, v11, s[20:23], 0 offen sc1
    s_sub_u32 s68, s68, 1
    s_waitcnt vmcnt(0)
    v_cmp_eq_u32 vcc, 0, v4
    s_cmp_eq_u32 s68, 0
    s_cbranch_scc1 LN_w2_out
    s_nop 2
    s_cbranch_vccnz LN_w2_loop
LN_w2_out:
    s_mov_b64 exec, -1
LN_w2_done:
    s_waitcnt vmcnt(0)
    s_barrier
    s_add_u32 s30, s93, 0
    buffer_load_dwordx4 a[96:99], v2, s[20:23], s30 offen offset:0 sc1
    buffer_load_dwordx4 a[100:103], v2, s[20:23], s30 offen offset:1024 sc1
    buffer_load_dwordx4 a[104:107], v2, s[20:23], s30 offen offset:2048 sc1
    buffer_load_dwordx4 a[108:111], v2, s[20:23], s30 offen offset:3072 sc1
    buffer_load_dwordx4 v[16:19], v3, s[20:23], s92 offen offset:0 sc1
    buffer_load_dwordx4 v[20:23], v3, s[20:23], s92 offen offset:16 sc1
    s_add_u32 s30, s93, 4096
    buffer_load_dwordx4 a[112:115], v2, s[20:23], s30 offen offset:0 sc1
    buffer_load_dwordx4 a[116:119], v2, s[20:23], s30 offen offset:1024 sc1
    buffer_load_dwordx4 a[120:123], v2, s[20:23], s30 offen offset:2048 sc1
    buffer_load_dwordx4 a[124:127], v2, s[20:23], s30 offen offset:3072 sc1
    s_add_u32 s30, s93, 8192
    buffer_load_dwordx4 a[128:131], v2, s[20:23], s30 offen offset:0 sc1
    buffer_load_dwordx4 a[132:135], v2, s[20:23], s30 offen offset:1024 sc1
    ds_read_b128 v[128:131], v8 offset:0
    ds_read_b128 v[132:135], v8 offset:32768
    ds_read_b128 v[136:139], v9 offset:0
    ds_read_b128 v[140:143], v8 offset:1024
    ds_read_b128 v[144:147], v8 offset:33792
    ds_read_b128 v[148:151], v9 offset:1024
    ds_read_b128 v[152:155], v8 offset:2048
    ds_read_b128 v[156:159], v8 offset:34816
    ds_read_b128 v[160:163], v9 offset:2048
    buffer_load_dwordx4 a[136:139], v2, s[20:23], s30 offen offset:2048 sc1
    s_waitcnt vmcnt(12) lgkmcnt(6)
    v_mfma_f32_16x16x32_bf16 v[48:51], v[128:131], a[96:99], 0
    ds_read_b128 v[164:167], v8 offset:3072
    v_mfma_f32_16x16x32_bf16 v[52:55], v[132:135], a[96:99], 0
    ds_read_b128 v[168:171], v8 offset:35840
    v_mfma_f32_16x16x32_bf16 v[56:59], v[136:139], a[96:99], 0
    ds_read_b128 v[172:175], v9 offset:3072
    buffer_load_dwordx4 a[140:143], v2, s[20:23], s30 offen offset:3072 sc1
    s_waitcnt vmcnt(12) lgkmcnt(6)
    v_mfma_f32_16x16x32_bf16 v[48:51], v[140:143], a[100:103], v[48:51]
    ds_read_b128 v[128:131], v8 offset:4096
    v_mfma_f32_16x16x32_bf16 v[52:55], v[144:147], a[100:103], v[52:55]
    ds_read_b128 v[132:135], v8 offset:36864
    v_mfma_f32_16x16x32_bf16 v[56:59], v[148:151], a[100:103], v[56:59]
    ds_read_b128 v[136:139], v9 offset:4096
    s_add_u32 s30, s93, 12288
    buffer_load_dwordx4 a[144:147], v2, s[20:23], s30 offen offset:0 sc1
    s_waitcnt vmcnt(12) lgkmcnt(6)
    v_mfma_f32_16x16x32_bf16 v[48:51], v[152:155], a[104:107], v[48:51]
    ds_read_b128 v[140:143], v8 offset:5120
    v_mfma_f32_16x16x32_bf16 v[52:55], v[156:159], a[104:107], v[52:55]
    ds_read_b128 v[144:147], v8 offset:37888
    v_mfma_f32_16x16x32_bf16 v[56:59], v[160:163], a[104:107], v[56:59]
    ds_read_b128 v[148:151], v9 offset:5120
    buffer_load_dwordx4 a[148:151], v2, s[20:23], s30 offen offset:1024 sc1
    s_waitcnt vmcnt(12) lgkmcnt(6)
    v_mfma_f32_16x16x32_bf16 v[48:51], v[164:167], a[108:111], v[48:51]
    ds_read_b128 v[152:155], v8 offset:6144
    v_mfma_f32_16x16x32_bf16 v[52:55], v[168:171], a[108:111], v[52:55]
    ds_read_b128 v[156:159], v8 offset:38912
    v_mfma_f32_16x16x32_bf16 v[56:59], v[172:175], a[108:111], v[56:59]
    ds_read_b128 v[160:163], v9 offset:6144
    buffer_load_dwordx4 a[152:155], v2, s[20:23], s30 offen offset:2048 sc1
    s_waitcnt vmcnt(10) lgkmcnt(6)
    v_mfma_f32_16x16x32_bf16 v[60:63], v[128:131], a[112:115], 0
    ds_read_b128 v[164:167], v8 offset:7168
    v_max3_f32 v24, v16, v17, v18
    v_max3_f32 v24, v24, v19, v20
    v_mfma_f32_16x16x32_bf16 v[64:67], v[132:135], a[112:115], 0
    ds_read_b128 v[168:171], v8 offset:39936
    v_max3_f32 v24, v24, v21, v22
    v_max_f32 v24, v24, v23
    v_mfma_f32_16x16x32_bf16 v[68:71], v[136:139], a[112:115], 0
    ds_read_b128 v[172:175], v9 offset:7168
    v_pk_add_f32 v[16:17], v[16:17], v[24:25] op_sel_hi:[1,0] neg_lo:[0,1] neg_hi:[0,1]
    v_pk_add_f32 v[18:19], v[18:19], v[24:25] op_sel_hi:[1,0] neg_lo:[0,1] neg_hi:[0,1]
    buffer_load_dwordx4 a[156:159], v2, s[20:23], s30 offen offset:3072 sc1
    s_waitcnt vmcnt(10) lgkmcnt(6)
    v_mfma_f32_16x16x32_bf16 v[60:63], v[140:143], a[116:119], v[60:63]
    ds_read_b128 v[128:131], v8 offset:8192
    v_pk_add_f32 v[20:21], v[20:21], v[24:25] op_sel_hi:[1,0] neg_lo:[0,1] neg_hi:[0,1]
    v_pk_add_f32 v[22:23], v[22:23], v[24:25] op_sel_hi:[1,0] neg_lo:[0,1] neg_hi:[0,1]
    v_mfma_f32_16x16x32_bf16 v[64:67], v[144:147], a[116:119], v[64:67]
    ds_read_b128 v[132:135], v8 offset:40960
    v_exp_f32 v16, v16
    v_exp_f32 v17, v17
    v_mfma_f32_16x16x32_bf16 v[68:71], v[148:151], a[116:119], v[68:71]
    ds_read_b128 v[136:139], v9 offset:8192
    v_exp_f32 v18, v18
    v_exp_f32 v19, v19
    s_add_u32 s30, s93, 16384
    buffer_load_dwordx4 a[160:163], v2, s[20:23], s30 offen offset:0 sc1
    s_waitcnt vmcnt(10) lgkmcnt(6)
    v_mfma_f32_16x16x32_bf16 v[60:63], v[152:155], a[120:123], v[60:63]
    ds_read_b128 v[140:143], v8 offset:9216
    v_exp_f32 v20, v20
    v_exp_f32 v21, v21
    v_mfma_f32_16x16x32_bf16 v[64:67], v[156:159], a[120:123], v[64:67]
    ds_read_b128 v[144:147], v8 offset:41984
    v_exp_f32 v22, v22
    v_exp_f32 v23, v23
    v_mfma_f32_16x16x32_bf16 v[68:71], v[160:163], a[120:123], v[68:71]
    ds_read_b128 v[148:151], v9 offset:9216
    v_pk_add_f32 v[26:27], v[16:17], v[18:19]
    v_pk_add_f32 v[28:29], v[20:21], v[22:23]
    buffer_load_dwordx4 a[164:167], v2, s[20:23], s30 offen offset:1024 sc1
    s_waitcnt vmcnt(10) lgkmcnt(6)
    v_mfma_f32_16x16x32_bf16 v[60:63], v[164:167], a[124:127], v[60:63]
    ds_read_b128 v[152:155], v8 offset:10240
    v_pk_add_f32 v[26:27], v[26:27], v[28:29]
    v_add_f32 v24, v26, v27
    v_mfma_f32_16x16x32_bf16 v[64:67], v[168:171], a[124:127], v[64:67]
    ds_read_b128 v[156:159], v8 offset:43008
    v_rcp_f32 v24, v24
    s_nop 0
    v_pk_mul_f32 v[16:17], v[16:17], v[24:25] op_sel_hi:[1,0]
    v_mfma_f32_16x16x32_bf16 v[68:71], v[172:175], a[124:127], v[68:71]
    ds_read_b128 v[160:163], v9 offset:10240
    v_pk_mul_f32 v[18:19], v[18:19], v[24:25] op_sel_hi:[1,0]
    v_pk_mul_f32 v[20:21], v[20:21], v[24:25] op_sel_hi:[1,0]
    buffer_load_dwordx4 a[168:171], v2, s[20:23], s30 offen offset:2048 sc1
    s_waitcnt vmcnt(10) lgkmcnt(6)
    v_mfma_f32_16x16x32_bf16 v[72:75], v[128:131], a[128:131], 0
    ds_read_b128 v[164:167], v8 offset:11264
    v_pk_mul_f32 v[22:23], v[22:23], v[24:25] op_sel_hi:[1,0]
    v_mfma_f32_16x16x32_bf16 v[76:79], v[132:135], a[128:131], 0
    ds_read_b128 v[168:171], v8 offset:44032
    v_mfma_f32_16x16x32_bf16 v[80:83], v[136:139], a[128:131], 0
    ds_read_b128 v[172:175], v9 offset:11264
    buffer_load_dwordx4 a[172:175], v2, s[20:23], s30 offen offset:3072 sc1
    s_waitcnt vmcnt(10) lgkmcnt(6)
    v_mfma_f32_16x16x32_bf16 v[72:75], v[140:143], a[132:135], v[72:75]
    ds_read_b128 v[128:131], v8 offset:12288
    v_mfma_f32_16x16x32_bf16 v[76:79], v[144:147], a[132:135], v[76:79]
    ds_read_b128 v[132:135], v8 offset:45056
    v_mfma_f32_16x16x32_bf16 v[80:83], v[148:151], a[132:135], v[80:83]
    ds_read_b128 v[136:139], v9 offset:12288
    s_add_u32 s30, s93, 20480
    buffer_load_dwordx4 a[176:179], v2, s[20:23], s30 offen offset:0 sc1
    s_waitcnt vmcnt(10) lgkmcnt(6)
    v_mfma_f32_16x16x32_bf16 v[72:75], v[152:155], a[136:139], v[72:75]
    ds_read_b128 v[140:143], v8 offset:13312
    v_mfma_f32_16x16x32_bf16 v[76:79], v[156:159], a[136:139], v[76:79]
    ds_read_b128 v[144:147], v8 offset:46080
    v_mfma_f32_16x16x32_bf16 v[80:83], v[160:163], a[136:139], v[80:83]
    ds_read_b128 v[148:151], v9 offset:13312
    buffer_load_dwordx4 a[180:183], v2, s[20:23], s30 offen offset:1024 sc1
    s_waitcnt vmcnt(10) lgkmcnt(6)
    v_mfma_f32_16x16x32_bf16 v[72:75], v[164:167], a[140:143], v[72:75]
    ds_read_b128 v[152:155], v8 offset:14336
    v_mfma_f32_16x16x32_bf16 v[76:79], v[168:171], a[140:143], v[76:79]
    ds_read_b128 v[156:159], v8 offset:47104
    v_mfma_f32_16x16x32_bf16 v[80:83], v[172:175], a[140:143], v[80:83]
    ds_read_b128 v[160:163], v9 offset:14336
    buffer_load_dwordx4 a[184:187], v2, s[20:23], s30 offen offset:2048 sc1
    s_waitcnt vmcnt(10) lgkmcnt(6)
    v_mfma_f32_16x16x32_bf16 v[84:87], v[128:131], a[144:147], 0
    ds_read_b128 v[164:167], v8 offset:15360
    v_mfma_f32_16x16x32_bf16 v[88:91], v[132:135], a[144:147], 0
    ds_read_b128 v[168:171], v8 offset:48128
    v_mfma_f32_16x16x32_bf16 v[92:95], v[136:139], a[144:147], 0
    ds_read_b128 v[172:175], v9 offset:15360
    buffer_load_dwordx4 a[188:191], v2, s[20:23], s30 offen offset:3072 sc1
    s_waitcnt vmcnt(10) lgkmcnt(6)
    v_mfma_f32_16x16x32_bf16 v[84:87], v[140:143], a[148:151], v[84:87]
    ds_read_b128 v[128:131], v8 offset:16384
    v_pk_mul_f32 v[32:33], v[48:49], v[16:17] op_sel:[0,0] op_sel_hi:[1,0]
    v_pk_mul_f32 v[34:35], v[50:51], v[16:17] op_sel:[0,0] op_sel_hi:[1,0]
    v_mfma_f32_16x16x32_bf16 v[88:91], v[144:147], a[148:151], v[88:91]
    ds_read_b128 v[132:135], v8 offset:49152
    v_pk_mul_f32 v[36:37], v[52:53], v[16:17] op_sel:[0,0] op_sel_hi:[1,0]
    v_pk_mul_f32 v[38:39], v[54:55], v[16:17] op_sel:[0,0] op_sel_hi:[1,0]
    v_mfma_f32_16x16x32_bf16 v[92:95], v[148:151], a[148:151], v[92:95]
    ds_read_b128 v[136:139], v9 offset:16384
    v_pk_mul_f32 v[40:41], v[56:57], v[16:17] op_sel:[0,0] op_sel_hi:[1,0]
    v_pk_mul_f32 v[42:43], v[58:59], v[16:17] op_sel:[0,0] op_sel_hi:[1,0]
    s_add_u32 s30, s93, 24576
    buffer_load_dwordx4 a[192:195], v2, s[20:23], s30 offen offset:0 sc1
    s_waitcnt vmcnt(10) lgkmcnt(6)
    v_mfma_f32_16x16x32_bf16 v[84:87], v[152:155], a[152:155], v[84:87]
    ds_read_b128 v[140:143], v8 offset:17408
    v_mfma_f32_16x16x32_bf16 v[88:91], v[156:159], a[152:155], v[88:91]
    ds_read_b128 v[144:147], v8 offset:50176
    v_mfma_f32_16x16x32_bf16 v[92:95], v[160:163], a[152:155], v[92:95]
    ds_read_b128 v[148:151], v9 offset:17408
    buffer_load_dwordx4 a[196:199], v2, s[20:23], s30 offen offset:1024 sc1
    s_waitcnt vmcnt(10) lgkmcnt(6)
    v_mfma_f32_16x16x32_bf16 v[84:87], v[164:167], a[156:159], v[84:87]
    ds_read_b128 v[152:155], v8 offset:18432
    v_mfma_f32_16x16x32_bf16 v[88:91], v[168:171], a[156:159], v[88:91]
    ds_read_b128 v[156:159], v8 offset:51200
    v_mfma_f32_16x16x32_bf16 v[92:95], v[172:175], a[156:159], v[92:95]
    ds_read_b128 v[160:163], v9 offset:18432
    buffer_load_dwordx4 a[200:203], v2, s[20:23], s30 offen offset:2048 sc1
    s_waitcnt vmcnt(10) lgkmcnt(6)
    v_mfma_f32_16x16x32_bf16 v[48:51], v[128:131], a[160:163], 0
    ds_read_b128 v[164:167], v8 offset:19456
    v_mfma_f32_16x16x32_bf16 v[52:55], v[132:135], a[160:163], 0
    ds_read_b128 v[168:171], v8 offset:52224
    v_mfma_f32_16x16x32_bf16 v[56:59], v[136:139], a[160:163], 0
    ds_read_b128 v[172:175], v9 offset:19456
    buffer_load_dwordx4 a[204:207], v2, s[20:23], s30 offen offset:3072 sc1
    s_waitcnt vmcnt(10) lgkmcnt(6)
    v_mfma_f32_16x16x32_bf16 v[48:51], v[140:143], a[164:167], v[48:51]
    ds_read_b128 v[128:131], v8 offset:20480
    v_pk_fma_f32 v[32:33], v[60:61], v[16:17], v[32:33] op_sel:[0,1,0] op_sel_hi:[1,1,1]
    v_pk_fma_f32 v[34:35], v[62:63], v[16:17], v[34:35] op_sel:[0,1,0] op_sel_hi:[1,1,1]
    v_mfma_f32_16x16x32_bf16 v[52:55], v[144:147], a[164:167], v[52:55]
    ds_read_b128 v[132:135], v8 offset:53248
    v_pk_fma_f32 v[36:37], v[64:65], v[16:17], v[36:37] op_sel:[0,1,0] op_sel_hi:[1,1,1]
    v_pk_fma_f32 v[38:39], v[66:67], v[16:17], v[38:39] op_sel:[0,1,0] op_sel_hi:[1,1,1]
    v_mfma_f32_16x16x32_bf16 v[56:59], v[148:151], a[164:167], v[56:59]
    ds_read_b128 v[136:139], v9 offset:20480
    v_pk_fma_f32 v[40:41], v[68:69], v[16:17], v[40:41] op_sel:[0,1,0] op_sel_hi:[1,1,1]
    v_pk_fma_f32 v[42:43], v[70:71], v[16:17], v[42:43] op_sel:[0,1,0] op_sel_hi:[1,1,1]
    s_add_u32 s30, s93, 28672
    buffer_load_dwordx4 a[208:211], v2, s[20:23], s30 offen offset:0 sc1
    s_waitcnt vmcnt(10) lgkmcnt(6)
    v_mfma_f32_16x16x32_bf16 v[48:51], v[152:155], a[168:171], v[48:51]
    ds_read_b128 v[140:143], v8 offset:21504
    v_mfma_f32_16x16x32_bf16 v[52:55], v[156:159], a[168:171], v[52:55]
    ds_read_b128 v[144:147], v8 offset:54272
    v_mfma_f32_16x16x32_bf16 v[56:59], v[160:163], a[168:171], v[56:59]
    ds_read_b128 v[148:151], v9 offset:21504
    buffer_load_dwordx4 a[212:215], v2, s[20:23], s30 offen offset:1024 sc1
    s_waitcnt vmcnt(10) lgkmcnt(6)
    v_mfma_f32_16x16x32_bf16 v[48:51], v[164:167], a[172:175], v[48:51]
    ds_read_b128 v[152:155], v8 offset:22528
    v_mfma_f32_16x16x32_bf16 v[52:55], v[168:171], a[172:175], v[52:55]
    ds_read_b128 v[156:159], v8 offset:55296
    v_mfma_f32_16x16x32_bf16 v[56:59], v[172:175], a[172:175], v[56:59]
    ds_read_b128 v[160:163], v9 offset:22528
    buffer_load_dwordx4 a[216:219], v2, s[20:23], s30 offen offset:2048 sc1
    s_waitcnt vmcnt(10) lgkmcnt(6)
    v_mfma_f32_16x16x32_bf16 v[60:63], v[128:131], a[176:179], 0
    ds_read_b128 v[164:167], v8 offset:23552
    v_mfma_f32_16x16x32_bf16 v[64:67], v[132:135], a[176:179], 0
    ds_read_b128 v[168:171], v8 offset:56320
    v_mfma_f32_16x16x32_bf16 v[68:71], v[136:139], a[176:179], 0
    ds_read_b128 v[172:175], v9 offset:23552
    buffer_load_dwordx4 a[220:223], v2, s[20:23], s30 offen offset:3072 sc1
    s_waitcnt vmcnt(10) lgkmcnt(6)
    v_mfma_f32_16x16x32_bf16 v[60:63], v[140:143], a[180:183], v[60:63]
    ds_read_b128 v[128:131], v8 offset:24576
    v_pk_fma_f32 v[32:33], v[72:73], v[18:19], v[32:33] op_sel:[0,0,0] op_sel_hi:[1,0,1]
    v_pk_fma_f32 v[34:35], v[74:75], v[18:19], v[34:35] op_sel:[0,0,0] op_sel_hi:[1,0,1]
    v_mfma_f32_16x16x32_bf16 v[64:67], v[144:147], a[180:183], v[64:67]
    ds_read_b128 v[132:135], v8 offset:57344
    v_pk_fma_f32 v[36:37], v[76:77], v[18:19], v[36:37] op_sel:[0,0,0] op_sel_hi:[1,0,1]
    v_pk_fma_f32 v[38:39], v[78:79], v[18:19], v[38:39] op_sel:[0,0,0] op_sel_hi:[1,0,1]
    v_mfma_f32_16x16x32_bf16 v[68:71], v[148:151], a[180:183], v[68:71]
    ds_read_b128 v[136:139], v9 offset:24576
    v_pk_fma_f32 v[40:41], v[80:81], v[18:19], v[40:41] op_sel:[0,0,0] op_sel_hi:[1,0,1]
    v_pk_fma_f32 v[42:43], v[82:83], v[18:19], v[42:43] op_sel:[0,0,0] op_sel_hi:[1,0,1]
    s_waitcnt vmcnt(9) lgkmcnt(6)
    v_mfma_f32_16x16x32_bf16 v[60:63], v[152:155], a[184:187], v[60:63]
    ds_read_b128 v[140:143], v8 offset:25600
    v_mfma_f32_16x16x32_bf16 v[64:67], v[156:159], a[184:187], v[64:67]
    ds_read_b128 v[144:147], v8 offset:58368
    v_mfma_f32_16x16x32_bf16 v[68:71], v[160:163], a[184:187], v[68:71]
    ds_read_b128 v[148:151], v9 offset:25600
    s_waitcnt vmcnt(8) lgkmcnt(6)
    v_mfma_f32_16x16x32_bf16 v[60:63], v[164:167], a[188:191], v[60:63]
    ds_read_b128 v[152:155], v8 offset:26624
    v_mfma_f32_16x16x32_bf16 v[64:67], v[168:171], a[188:191], v[64:67]
    ds_read_b128 v[156:159], v8 offset:59392
    v_mfma_f32_16x16x32_bf16 v[68:71], v[172:175], a[188:191], v[68:71]
    ds_read_b128 v[160:163], v9 offset:26624
    s_waitcnt vmcnt(7) lgkmcnt(6)
    v_mfma_f32_16x16x32_bf16 v[72:75], v[128:131], a[192:195], 0
    ds_read_b128 v[164:167], v8 offset:27648
    v_mfma_f32_16x16x32_bf16 v[76:79], v[132:135], a[192:195], 0
    ds_read_b128 v[168:171], v8 offset:60416
    v_mfma_f32_16x16x32_bf16 v[80:83], v[136:139], a[192:195], 0
    ds_read_b128 v[172:175], v9 offset:27648
    s_waitcnt vmcnt(6) lgkmcnt(6)
    v_mfma_f32_16x16x32_bf16 v[72:75], v[140:143], a[196:199], v[72:75]
    ds_read_b128 v[128:131], v8 offset:28672
    v_pk_fma_f32 v[32:33], v[84:85], v[18:19], v[32:33] op_sel:[0,1,0] op_sel_hi:[1,1,1]
    v_pk_fma_f32 v[34:35], v[86:87], v[18:19], v[34:35] op_sel:[0,1,0] op_sel_hi:[1,1,1]
    v_mfma_f32_16x16x32_bf16 v[76:79], v[144:147], a[196:199], v[76:79]
    ds_read_b128 v[132:135], v8 offset:61440
    v_pk_fma_f32 v[36:37], v[88:89], v[18:19], v[36:37] op_sel:[0,1,0] op_sel_hi:[1,1,1]
    v_pk_fma_f32 v[38:39], v[90:91], v[18:19], v[38:39] op_sel:[0,1,0] op_sel_hi:[1,1,1]
    v_mfma_f32_16x16x32_bf16 v[80:83], v[148:151], a[196:199], v[80:83]
    ds_read_b128 v[136:139], v9 offset:28672
    v_pk_fma_f32 v[40:41], v[92:93], v[18:19], v[40:41] op_sel:[0,1,0] op_sel_hi:[1,1,1]
    v_pk_fma_f32 v[42:43], v[94:95], v[18:19], v[42:43] op_sel:[0,1,0] op_sel_hi:[1,1,1]
    s_waitcnt vmcnt(5) lgkmcnt(6)
    v_mfma_f32_16x16x32_bf16 v[72:75], v[152:155], a[200:203], v[72:75]
    ds_read_b128 v[140:143], v8 offset:29696
    v_mfma_f32_16x16x32_bf16 v[76:79], v[156:159], a[200:203], v[76:79]
    ds_read_b128 v[144:147], v8 offset:62464
    v_mfma_f32_16x16x32_bf16 v[80:83], v[160:163], a[200:203], v[80:83]
    ds_read_b128 v[148:151], v9 offset:29696
    s_waitcnt vmcnt(4) lgkmcnt(6)
    v_mfma_f32_16x16x32_bf16 v[72:75], v[164:167], a[204:207], v[72:75]
    ds_read_b128 v[152:155], v8 offset:30720
    v_mfma_f32_16x16x32_bf16 v[76:79], v[168:171], a[204:207], v[76:79]
    ds_read_b128 v[156:159], v8 offset:63488
    v_mfma_f32_16x16x32_bf16 v[80:83], v[172:175], a[204:207], v[80:83]
    ds_read_b128 v[160:163], v9 offset:30720
    s_waitcnt vmcnt(3) lgkmcnt(6)
    v_mfma_f32_16x16x32_bf16 v[84:87], v[128:131], a[208:211], 0
    ds_read_b128 v[164:167], v8 offset:31744
    v_mfma_f32_16x16x32_bf16 v[88:91], v[132:135], a[208:211], 0
    ds_read_b128 v[168:171], v8 offset:64512
    v_mfma_f32_16x16x32_bf16 v[92:95], v[136:139], a[208:211], 0
    ds_read_b128 v[172:175], v9 offset:31744
    s_waitcnt vmcnt(2) lgkmcnt(6)
    v_mfma_f32_16x16x32_bf16 v[84:87], v[140:143], a[212:215], v[84:87]
    v_pk_fma_f32 v[32:33], v[48:49], v[20:21], v[32:33] op_sel:[0,0,0] op_sel_hi:[1,0,1]
    v_pk_fma_f32 v[34:35], v[50:51], v[20:21], v[34:35] op_sel:[0,0,0] op_sel_hi:[1,0,1]
    v_mfma_f32_16x16x32_bf16 v[88:91], v[144:147], a[212:215], v[88:91]
    v_pk_fma_f32 v[36:37], v[52:53], v[20:21], v[36:37] op_sel:[0,0,0] op_sel_hi:[1,0,1]
    v_pk_fma_f32 v[38:39], v[54:55], v[20:21], v[38:39] op_sel:[0,0,0] op_sel_hi:[1,0,1]
    v_mfma_f32_16x16x32_bf16 v[92:95], v[148:151], a[212:215], v[92:95]
    v_pk_fma_f32 v[40:41], v[56:57], v[20:21], v[40:41] op_sel:[0,0,0] op_sel_hi:[1,0,1]
    v_pk_fma_f32 v[42:43], v[58:59], v[20:21], v[42:43] op_sel:[0,0,0] op_sel_hi:[1,0,1]
    s_waitcnt vmcnt(1) lgkmcnt(3)
    v_mfma_f32_16x16x32_bf16 v[84:87], v[152:155], a[216:219], v[84:87]
    v_mfma_f32_16x16x32_bf16 v[88:91], v[156:159], a[216:219], v[88:91]
    v_mfma_f32_16x16x32_bf16 v[92:95], v[160:163], a[216:219], v[92:95]
    s_waitcnt vmcnt(0) lgkmcnt(0)
    v_mfma_f32_16x16x32_bf16 v[84:87], v[164:167], a[220:223], v[84:87]
    v_mfma_f32_16x16x32_bf16 v[88:91], v[168:171], a[220:223], v[88:91]
    v_mfma_f32_16x16x32_bf16 v[92:95], v[172:175], a[220:223], v[92:95]
    v_pk_fma_f32 v[32:33], v[60:61], v[20:21], v[32:33] op_sel:[0,1,0] op_sel_hi:[1,1,1]
    v_pk_fma_f32 v[34:35], v[62:63], v[20:21], v[34:35] op_sel:[0,1,0] op_sel_hi:[1,1,1]
    v_pk_fma_f32 v[36:37], v[64:65], v[20:21], v[36:37] op_sel:[0,1,0] op_sel_hi:[1,1,1]
    v_pk_fma_f32 v[38:39], v[66:67], v[20:21], v[38:39] op_sel:[0,1,0] op_sel_hi:[1,1,1]
    v_pk_fma_f32 v[40:41], v[68:69], v[20:21], v[40:41] op_sel:[0,1,0] op_sel_hi:[1,1,1]
    v_pk_fma_f32 v[42:43], v[70:71], v[20:21], v[42:43] op_sel:[0,1,0] op_sel_hi:[1,1,1]
    v_pk_fma_f32 v[32:33], v[72:73], v[22:23], v[32:33] op_sel:[0,0,0] op_sel_hi:[1,0,1]
    v_pk_fma_f32 v[34:35], v[74:75], v[22:23], v[34:35] op_sel:[0,0,0] op_sel_hi:[1,0,1]
    v_pk_fma_f32 v[36:37], v[76:77], v[22:23], v[36:37] op_sel:[0,0,0] op_sel_hi:[1,0,1]
    v_pk_fma_f32 v[38:39], v[78:79], v[22:23], v[38:39] op_sel:[0,0,0] op_sel_hi:[1,0,1]
    v_pk_fma_f32 v[40:41], v[80:81], v[22:23], v[40:41] op_sel:[0,0,0] op_sel_hi:[1,0,1]
    v_pk_fma_f32 v[42:43], v[82:83], v[22:23], v[42:43] op_sel:[0,0,0] op_sel_hi:[1,0,1]
    v_pk_fma_f32 v[32:33], v[84:85], v[22:23], v[32:33] op_sel:[0,1,0] op_sel_hi:[1,1,1]
    v_pk_fma_f32 v[34:35], v[86:87], v[22:23], v[34:35] op_sel:[0,1,0] op_sel_hi:[1,1,1]
    v_pk_fma_f32 v[36:37], v[88:89], v[22:23], v[36:37] op_sel:[0,1,0] op_sel_hi:[1,1,1]
    v_pk_fma_f32 v[38:39], v[90:91], v[22:23], v[38:39] op_sel:[0,1,0] op_sel_hi:[1,1,1]
    v_pk_fma_f32 v[40:41], v[92:93], v[22:23], v[40:41] op_sel:[0,1,0] op_sel_hi:[1,1,1]
    v_pk_fma_f32 v[42:43], v[94:95], v[22:23], v[42:43] op_sel:[0,1,0] op_sel_hi:[1,1,1]
LN_pv_check:
    v_pk_add_f32 v[24:25], v[32:33], v[34:35]
    v_pk_add_f32 v[26:27], v[36:37], v[38:39]
    v_pk_add_f32 v[28:29], v[40:41], v[42:43]
    v_pk_add_f32 v[24:25], v[24:25], v[26:27]
    v_pk_add_f32 v[24:25], v[24:25], v[28:29]
    v_cmp_u_f32 vcc, v24, v25
    v_cvt_pk_bf16_f32 v48, v32, v33
    v_cvt_pk_bf16_f32 v49, v34, v35
    v_cvt_pk_bf16_f32 v50, v36, v37
    v_cvt_pk_bf16_f32 v51, v38, v39
    v_cvt_pk_bf16_f32 v52, v40, v41
    v_cvt_pk_bf16_f32 v53, v42, v43
    s_cbranch_vccnz LN_pv_retry0
LN_pv_cont:
    v_lshlrev_b32 v32, 16, v48
    v_and_b32 v33, 0xffff0000, v48
    v_lshlrev_b32 v34, 16, v49
    v_and_b32 v35, 0xffff0000, v49
    v_lshlrev_b32 v36, 16, v50
    v_and_b32 v37, 0xffff0000, v50
    v_lshlrev_b32 v38, 16, v51
    v_and_b32 v39, 0xffff0000, v51
    v_lshlrev_b32 v40, 16, v52
    v_and_b32 v41, 0xffff0000, v52
    v_lshlrev_b32 v42, 16, v53
    v_and_b32 v43, 0xffff0000, v53
    v_pk_mul_f32 v[32:33], v[32:33], v[224:225]
    v_pk_mul_f32 v[34:35], v[34:35], v[226:227]
    v_pk_mul_f32 v[36:37], v[36:37], v[228:229]
    v_pk_mul_f32 v[38:39], v[38:39], v[230:231]
    v_pk_mul_f32 v[40:41], v[40:41], v[232:233]
    v_pk_mul_f32 v[42:43], v[42:43], v[234:235]
    v_cvt_pk_bf16_f32 v48, v32, v33
    v_cvt_pk_bf16_f32 v49, v34, v35
    v_cvt_pk_bf16_f32 v50, v36, v37
    v_cvt_pk_bf16_f32 v51, v38, v39
    v_cvt_pk_bf16_f32 v52, v40, v41
    v_cvt_pk_bf16_f32 v53, v42, v43
    v_lshlrev_b32 v56, 16, v216
    v_and_b32 v57, 0xffff0000, v216
    v_lshlrev_b32 v32, 16, v48
    v_and_b32 v33, 0xffff0000, v48
    v_lshlrev_b32 v58, 16, v217
    v_and_b32 v59, 0xffff0000, v217
    v_lshlrev_b32 v34, 16, v49
    v_and_b32 v35, 0xffff0000, v49
    v_lshlrev_b32 v60, 16, v218
    v_and_b32 v61, 0xffff0000, v218
    v_lshlrev_b32 v36, 16, v50
    v_and_b32 v37, 0xffff0000, v50
    v_lshlrev_b32 v62, 16, v219
    v_and_b32 v63, 0xffff0000, v219
    v_lshlrev_b32 v38, 16, v51
    v_and_b32 v39, 0xffff0000, v51
    v_lshlrev_b32 v64, 16, v220
    v_and_b32 v65, 0xffff0000, v220
    v_lshlrev_b32 v40, 16, v52
    v_and_b32 v41, 0xffff0000, v52
    v_lshlrev_b32 v66, 16, v221
    v_and_b32 v67, 0xffff0000, v221
    v_lshlrev_b32 v42, 16, v53
    v_and_b32 v43, 0xffff0000, v53
    v_pk_add_f32 v[32:33], v[32:33], v[56:57]
    v_pk_add_f32 v[34:35], v[34:35], v[58:59]
    v_pk_add_f32 v[36:37], v[36:37], v[60:61]
    v_pk_add_f32 v[38:39], v[38:39], v[62:63]
    v_pk_add_f32 v[40:41], v[40:41], v[64:65]
    v_pk_add_f32 v[42:43], v[42:43], v[66:67]
    v_cvt_pk_bf16_f32 v216, v32, v33
    v_cvt_pk_bf16_f32 v217, v34, v35
    v_cvt_pk_bf16_f32 v218, v36, v37
    v_cvt_pk_bf16_f32 v219, v38, v39
    v_cvt_pk_bf16_f32 v220, v40, v41
    v_cvt_pk_bf16_f32 v221, v42, v43
    buffer_store_dwordx2 v[216:217], v12, s[48:51], s66 offen offset:0
    buffer_store_dwordx2 v[218:219], v12, s[48:51], s66 offen offset:32
    buffer_store_dwordx2 v[220:221], v12, s[48:51], s66 offen offset:64
LN_exit:
    s_endpgm
LN_hot_end:
LN_s_retry0:
    s_cmp_eq_u32 s94, 0
    s_cbranch_scc1 LN_s_cont
    s_waitcnt vmcnt(0)
    s_sub_u32 s94, s94, 1
    s_branch LN_s_retry
LN_pv_retry0:
    s_cmp_eq_u32 s95, 0
    s_cbranch_scc1 LN_pv_cont
    s_sub_u32 s95, s95, 1
    s_mov_b32 s99, 51200
    s_add_u32 m0, s99, 0
    s_add_u32 s32, s89, 0
    buffer_load_dwordx4 v2, s[20:23], s32 offen offset:0 sc1 lds
    buffer_load_dwordx4 v2, s[20:23], s32 offen offset:1024 sc1 lds
    buffer_load_dwordx4 v2, s[20:23], s32 offen offset:2048 sc1 lds
    buffer_load_dwordx4 v2, s[20:23], s32 offen offset:3072 sc1 lds
    s_add_u32 m0, s99, 4096
    s_add_u32 s32, s89, 4096
    buffer_load_dwordx4 v2, s[20:23], s32 offen offset:0 sc1 lds
    buffer_load_dwordx4 v2, s[20:23], s32 offen offset:1024 sc1 lds
    buffer_load_dwordx4 v2, s[20:23], s32 offen offset:2048 sc1 lds
    buffer_load_dwordx4 v2, s[20:23], s32 offen offset:3072 sc1 lds
    s_add_u32 m0, s99, 8192
    s_add_u32 s32, s89, 8192
    buffer_load_dwordx4 v2, s[20:23], s32 offen offset:0 sc1 lds
    buffer_load_dwordx4 v2, s[20:23], s32 offen offset:1024 sc1 lds
    buffer_load_dwordx4 v2, s[20:23], s32 offen offset:2048 sc1 lds
    buffer_load_dwordx4 v2, s[20:23], s32 offen offset:3072 sc1 lds
    s_add_u32 m0, s99, 12288
    s_add_u32 s32, s89, 12288
    buffer_load_dwordx4 v2, s[20:23], s32 offen offset:0 sc1 lds
    buffer_load_dwordx4 v2, s[20:23], s32 offen offset:1024 sc1 lds
    buffer_load_dwordx4 v2, s[20:23], s32 offen offset:2048 sc1 lds
    buffer_load_dwordx4 v2, s[20:23], s32 offen offset:3072 sc1 lds
    s_add_u32 m0, s99, 16384
    s_add_u32 s32, s89, 16384
    buffer_load_dwordx4 v2, s[20:23], s32 offen offset:0 sc1 lds
    buffer_load_dwordx4 v2, s[20:23], s32 offen offset:1024 sc1 lds
    buffer_load_dwordx4 v2, s[20:23], s32 offen offset:2048 sc1 lds
    buffer_load_dwordx4 v2, s[20:23], s32 offen offset:3072 sc1 lds
    s_add_u32 m0, s99, 20480
    s_add_u32 s32, s89, 20480
    buffer_load_dwordx4 v2, s[20:23], s32 offen offset:0 sc1 lds
    buffer_load_dwordx4 v2, s[20:23], s32 offen offset:1024 sc1 lds
    buffer_load_dwordx4 v2, s[20:23], s32 offen offset:2048 sc1 lds
    buffer_load_dwordx4 v2, s[20:23], s32 offen offset:3072 sc1 lds
    s_add_u32 m0, s99, 24576
    s_add_u32 s32, s89, 24576
    buffer_load_dwordx4 v2, s[20:23], s32 offen offset:0 sc1 lds
    buffer_load_dwordx4 v2, s[20:23], s32 offen offset:1024 sc1 lds
    buffer_load_dwordx4 v2, s[20:23], s32 offen offset:2048 sc1 lds
    buffer_load_dwordx4 v2, s[20:23], s32 offen offset:3072 sc1 lds
    s_add_u32 m0, s99, 28672
    s_add_u32 s32, s89, 28672
    buffer_load_dwordx4 v2, s[20:23], s32 offen offset:0 sc1 lds
    buffer_load_dwordx4 v2, s[20:23], s32 offen offset:1024 sc1 lds
    buffer_load_dwordx4 v2, s[20:23], s32 offen offset:2048 sc1 lds
    buffer_load_dwordx4 v2, s[20:23], s32 offen offset:3072 sc1 lds
    s_add_u32 m0, s99, 32768
    s_add_u32 s32, s89, 32768
    buffer_load_dwordx4 v2, s[20:23], s32 offen offset:0 sc1 lds
    buffer_load_dwordx4 v2, s[20:23], s32 offen offset:1024 sc1 lds
    buffer_load_dwordx4 v2, s[20:23], s32 offen offset:2048 sc1 lds
    buffer_load_dwordx4 v2, s[20:23], s32 offen offset:3072 sc1 lds
    s_add_u32 m0, s99, 36864
    s_add_u32 s32, s89, 36864
    buffer_load_dwordx4 v2, s[20:23], s32 offen offset:0 sc1 lds
    buffer_load_dwordx4 v2, s[20:23], s32 offen offset:1024 sc1 lds
    buffer_load_dwordx4 v2, s[20:23], s32 offen offset:2048 sc1 lds
    buffer_load_dwordx4 v2, s[20:23], s32 offen offset:3072 sc1 lds
    s_add_u32 m0, s99, 40960
    s_add_u32 s32, s89, 40960
    buffer_load_dwordx4 v2, s[20:23], s32 offen offset:0 sc1 lds
    buffer_load_dwordx4 v2, s[20:23], s32 offen offset:1024 sc1 lds
    buffer_load_dwordx4 v2, s[20:23], s32 offen offset:2048 sc1 lds
    buffer_load_dwordx4 v2, s[20:23], s32 offen offset:3072 sc1 lds
    s_add_u32 m0, s99, 45056
    s_add_u32 s32, s89, 45056
    buffer_load_dwordx4 v2, s[20:23], s32 offen offset:0 sc1 lds
    buffer_load_dwordx4 v2, s[20:23], s32 offen offset:1024 sc1 lds
    buffer_load_dwordx4 v2, s[20:23], s32 offen offset:2048 sc1 lds
    buffer_load_dwordx4 v2, s[20:23], s32 offen offset:3072 sc1 lds
    s_waitcnt vmcnt(0)
    s_add_u32 m0, s99, 49152
    s_add_u32 s32, s89, 49152
    buffer_load_dwordx4 v2, s[20:23], s32 offen offset:0 sc1 lds
    buffer_load_dwordx4 v2, s[20:23], s32 offen offset:1024 sc1 lds
    buffer_load_dwordx4 v2, s[20:23], s32 offen offset:2048 sc1 lds
    buffer_load_dwordx4 v2, s[20:23], s32 offen offset:3072 sc1 lds
    s_add_u32 m0, s99, 53248
    s_add_u32 s32, s89, 53248
    buffer_load_dwordx4 v2, s[20:23], s32 offen offset:0 sc1 lds
    buffer_load_dwordx4 v2, s[20:23], s32 offen offset:1024 sc1 lds
    buffer_load_dwordx4 v2, s[20:23], s32 offen offset:2048 sc1 lds
    buffer_load_dwordx4 v2, s[20:23], s32 offen offset:3072 sc1 lds
    s_add_u32 m0, s99, 57344
    s_add_u32 s32, s89, 57344
    buffer_load_dwordx4 v2, s[20:23], s32 offen offset:0 sc1 lds
    buffer_load_dwordx4 v2, s[20:23], s32 offen offset:1024 sc1 lds
    buffer_load_dwordx4 v2, s[20:23], s32 offen offset:2048 sc1 lds
    buffer_load_dwordx4 v2, s[20:23], s32 offen offset:3072 sc1 lds
    s_add_u32 m0, s99, 61440
    s_add_u32 s32, s89, 61440
    buffer_load_dwordx4 v2, s[20:23], s32 offen offset:0 sc1 lds
    buffer_load_dwordx4 v2, s[20:23], s32 offen offset:1024 sc1 lds
    buffer_load_dwordx4 v2, s[20:23], s32 offen offset:2048 sc1 lds
    buffer_load_dwordx4 v2, s[20:23], s32 offen offset:3072 sc1 lds
    s_add_u32 m0, s99, 65536
    s_add_u32 s32, s89, 65536
    buffer_load_dwordx4 v2, s[20:23], s32 offen offset:0 sc1 lds
    buffer_load_dwordx4 v2, s[20:23], s32 offen offset:1024 sc1 lds
    buffer_load_dwordx4 v2, s[20:23], s32 offen offset:2048 sc1 lds
    buffer_load_dwordx4 v2, s[20:23], s32 offen offset:3072 sc1 lds
    s_add_u32 m0, s99, 69632
    s_add_u32 s32, s89, 69632
    buffer_load_dwordx4 v2, s[20:23], s32 offen offset:0 sc1 lds
    buffer_load_dwordx4 v2, s[20:23], s32 offen offset:1024 sc1 lds
    buffer_load_dwordx4 v2, s[20:23], s32 offen offset:2048 sc1 lds
    buffer_load_dwordx4 v2, s[20:23], s32 offen offset:3072 sc1 lds
    s_add_u32 m0, s99, 73728
    s_add_u32 s32, s89, 73728
    buffer_load_dwordx4 v2, s[20:23], s32 offen offset:0 sc1 lds
    buffer_load_dwordx4 v2, s[20:23], s32 offen offset:1024 sc1 lds
    buffer_load_dwordx4 v2, s[20:23], s32 offen offset:2048 sc1 lds
    buffer_load_dwordx4 v2, s[20:23], s32 offen offset:3072 sc1 lds
    s_add_u32 m0, s99, 77824
    s_add_u32 s32, s89, 77824
    buffer_load_dwordx4 v2, s[20:23], s32 offen offset:0 sc1 lds
    buffer_load_dwordx4 v2, s[20:23], s32 offen offset:1024 sc1 lds
    buffer_load_dwordx4 v2, s[20:23], s32 offen offset:2048 sc1 lds
    buffer_load_dwordx4 v2, s[20:23], s32 offen offset:3072 sc1 lds
    s_add_u32 m0, s99, 81920
    s_add_u32 s32, s89, 81920
    buffer_load_dwordx4 v2, s[20:23], s32 offen offset:0 sc1 lds
    buffer_load_dwordx4 v2, s[20:23], s32 offen offset:1024 sc1 lds
    buffer_load_dwordx4 v2, s[20:23], s32 offen offset:2048 sc1 lds
    buffer_load_dwordx4 v2, s[20:23], s32 offen offset:3072 sc1 lds
    s_add_u32 m0, s99, 86016
    s_add_u32 s32, s89, 86016
    buffer_load_dwordx4 v2, s[20:23], s32 offen offset:0 sc1 lds
    buffer_load_dwordx4 v2, s[20:23], s32 offen offset:1024 sc1 lds
    buffer_load_dwordx4 v2, s[20:23], s32 offen offset:2048 sc1 lds
    buffer_load_dwordx4 v2, s[20:23], s32 offen offset:3072 sc1 lds
    s_add_u32 m0, s99, 90112
    s_add_u32 s32, s89, 90112
    buffer_load_dwordx4 v2, s[20:23], s32 offen offset:0 sc1 lds
    buffer_load_dwordx4 v2, s[20:23], s32 offen offset:1024 sc1 lds
    buffer_load_dwordx4 v2, s[20:23], s32 offen offset:2048 sc1 lds
    buffer_load_dwordx4 v2, s[20:23], s32 offen offset:3072 sc1 lds
    s_add_u32 m0, s99, 94208
    s_add_u32 s32, s89, 94208
    buffer_load_dwordx4 v2, s[20:23], s32 offen offset:0 sc1 lds
    buffer_load_dwordx4 v2, s[20:23], s32 offen offset:1024 sc1 lds
    buffer_load_dwordx4 v2, s[20:23], s32 offen offset:2048 sc1 lds
    buffer_load_dwordx4 v2, s[20:23], s32 offen offset:3072 sc1 lds
    s_waitcnt vmcnt(0)
    s_waitcnt vmcnt(0)
    s_add_u32 s30, s93, 0
    buffer_load_dwordx4 a[96:99], v2, s[20:23], s30 offen offset:0 sc1
    buffer_load_dwordx4 a[100:103], v2, s[20:23], s30 offen offset:1024 sc1
    buffer_load_dwordx4 a[104:107], v2, s[20:23], s30 offen offset:2048 sc1
    buffer_load_dwordx4 a[108:111], v2, s[20:23], s30 offen offset:3072 sc1
    buffer_load_dwordx4 v[16:19], v3, s[20:23], s92 offen offset:0 sc1
    buffer_load_dwordx4 v[20:23], v3, s[20:23], s92 offen offset:16 sc1
    s_add_u32 s30, s93, 4096
    buffer_load_dwordx4 a[112:115], v2, s[20:23], s30 offen offset:0 sc1
    buffer_load_dwordx4 a[116:119], v2, s[20:23], s30 offen offset:1024 sc1
    buffer_load_dwordx4 a[120:123], v2, s[20:23], s30 offen offset:2048 sc1
    buffer_load_dwordx4 a[124:127], v2, s[20:23], s30 offen offset:3072 sc1
    s_add_u32 s30, s93, 8192
    buffer_load_dwordx4 a[128:131], v2, s[20:23], s30 offen offset:0 sc1
    buffer_load_dwordx4 a[132:135], v2, s[20:23], s30 offen offset:1024 sc1
    ds_read_b128 v[128:131], v8 offset:0
    ds_read_b128 v[132:135], v8 offset:32768
    ds_read_b128 v[136:139], v9 offset:0
    ds_read_b128 v[140:143], v8 offset:1024
    ds_read_b128 v[144:147], v8 offset:33792
    ds_read_b128 v[148:151], v9 offset:1024
    ds_read_b128 v[152:155], v8 offset:2048
    ds_read_b128 v[156:159], v8 offset:34816
    ds_read_b128 v[160:163], v9 offset:2048
    buffer_load_dwordx4 a[136:139], v2, s[20:23], s30 offen offset:2048 sc1
    s_waitcnt vmcnt(12) lgkmcnt(6)
    v_mfma_f32_16x16x32_bf16 v[48:51], v[128:131], a[96:99], 0
    ds_read_b128 v[164:167], v8 offset:3072
    v_mfma_f32_16x16x32_bf16 v[52:55], v[132:135], a[96:99], 0
    ds_read_b128 v[168:171], v8 offset:35840
    v_mfma_f32_16x16x32_bf16 v[56:59], v[136:139], a[96:99], 0
    ds_read_b128 v[172:175], v9 offset:3072
    buffer_load_dwordx4 a[140:143], v2, s[20:23], s30 offen offset:3072 sc1
    s_waitcnt vmcnt(12) lgkmcnt(6)
    v_mfma_f32_16x16x32_bf16 v[48:51], v[140:143], a[100:103], v[48:51]
    ds_read_b128 v[128:131], v8 offset:4096
    v_mfma_f32_16x16x32_bf16 v[52:55], v[144:147], a[100:103], v[52:55]
    ds_read_b128 v[132:135], v8 offset:36864
    v_mfma_f32_16x16x32_bf16 v[56:59], v[148:151], a[100:103], v[56:59]
    ds_read_b128 v[136:139], v9 offset:4096
    s_add_u32 s30, s93, 12288
    buffer_load_dwordx4 a[144:147], v2, s[20:23], s30 offen offset:0 sc1
    s_waitcnt vmcnt(12) lgkmcnt(6)
    v_mfma_f32_16x16x32_bf16 v[48:51], v[152:155], a[104:107], v[48:51]
    ds_read_b128 v[140:143], v8 offset:5120
    v_mfma_f32_16x16x32_bf16 v[52:55], v[156:159], a[104:107], v[52:55]
    ds_read_b128 v[144:147], v8 offset:37888
    v_mfma_f32_16x16x32_bf16 v[56:59], v[160:163], a[104:107], v[56:59]
    ds_read_b128 v[148:151], v9 offset:5120
    buffer_load_dwordx4 a[148:151], v2, s[20:23], s30 offen offset:1024 sc1
    s_waitcnt vmcnt(12) lgkmcnt(6)
    v_mfma_f32_16x16x32_bf16 v[48:51], v[164:167], a[108:111], v[48:51]
    ds_read_b128 v[152:155], v8 offset:6144
    v_mfma_f32_16x16x32_bf16 v[52:55], v[168:171], a[108:111], v[52:55]
    ds_read_b128 v[156:159], v8 offset:38912
    v_mfma_f32_16x16x32_bf16 v[56:59], v[172:175], a[108:111], v[56:59]
    ds_read_b128 v[160:163], v9 offset:6144
    buffer_load_dwordx4 a[152:155], v2, s[20:23], s30 offen offset:2048 sc1
    s_waitcnt vmcnt(10) lgkmcnt(6)
    v_mfma_f32_16x16x32_bf16 v[60:63], v[128:131], a[112:115], 0
    ds_read_b128 v[164:167], v8 offset:7168
    v_max3_f32 v24, v16, v17, v18
    v_max3_f32 v24, v24, v19, v20
    v_mfma_f32_16x16x32_bf16 v[64:67], v[132:135], a[112:115], 0
    ds_read_b128 v[168:171], v8 offset:39936
    v_max3_f32 v24, v24, v21, v22
    v_max_f32 v24, v24, v23
    v_mfma_f32_16x16x32_bf16 v[68:71], v[136:139], a[112:115], 0
    ds_read_b128 v[172:175], v9 offset:7168
    v_pk_add_f32 v[16:17], v[16:17], v[24:25] op_sel_hi:[1,0] neg_lo:[0,1] neg_hi:[0,1]
    v_pk_add_f32 v[18:19], v[18:19], v[24:25] op_sel_hi:[1,0] neg_lo:[0,1] neg_hi:[0,1]
    buffer_load_dwordx4 a[156:159], v2, s[20:23], s30 offen offset:3072 sc1
    s_waitcnt vmcnt(10) lgkmcnt(6)
    v_mfma_f32_16x16x32_bf16 v[60:63], v[140:143], a[116:119], v[60:63]
    ds_read_b128 v[128:131], v8 offset:8192
    v_pk_add_f32 v[20:21], v[20:21], v[24:25] op_sel_hi:[1,0] neg_lo:[0,1] neg_hi:[0,1]
    v_pk_add_f32 v[22:23], v[22:23], v[24:25] op_sel_hi:[1,0] neg_lo:[0,1] neg_hi:[0,1]
    v_mfma_f32_16x16x32_bf16 v[64:67], v[144:147], a[116:119], v[64:67]
    ds_read_b128 v[132:135], v8 offset:40960
    v_exp_f32 v16, v16
    v_exp_f32 v17, v17
    v_mfma_f32_16x16x32_bf16 v[68:71], v[148:151], a[116:119], v[68:71]
    ds_read_b128 v[136:139], v9 offset:8192
    v_exp_f32 v18, v18
    v_exp_f32 v19, v19
    s_add_u32 s30, s93, 16384
    buffer_load_dwordx4 a[160:163], v2, s[20:23], s30 offen offset:0 sc1
    s_waitcnt vmcnt(10) lgkmcnt(6)
    v_mfma_f32_16x16x32_bf16 v[60:63], v[152:155], a[120:123], v[60:63]
    ds_read_b128 v[140:143], v8 offset:9216
    v_exp_f32 v20, v20
    v_exp_f32 v21, v21
    v_mfma_f32_16x16x32_bf16 v[64:67], v[156:159], a[120:123], v[64:67]
    ds_read_b128 v[144:147], v8 offset:41984
    v_exp_f32 v22, v22
    v_exp_f32 v23, v23
    v_mfma_f32_16x16x32_bf16 v[68:71], v[160:163], a[120:123], v[68:71]
    ds_read_b128 v[148:151], v9 offset:9216
    v_pk_add_f32 v[26:27], v[16:17], v[18:19]
    v_pk_add_f32 v[28:29], v[20:21], v[22:23]
    buffer_load_dwordx4 a[164:167], v2, s[20:23], s30 offen offset:1024 sc1
    s_waitcnt vmcnt(10) lgkmcnt(6)
    v_mfma_f32_16x16x32_bf16 v[60:63], v[164:167], a[124:127], v[60:63]
    ds_read_b128 v[152:155], v8 offset:10240
    v_pk_add_f32 v[26:27], v[26:27], v[28:29]
    v_add_f32 v24, v26, v27
    v_mfma_f32_16x16x32_bf16 v[64:67], v[168:171], a[124:127], v[64:67]
    ds_read_b128 v[156:159], v8 offset:43008
    v_rcp_f32 v24, v24
    s_nop 0
    v_pk_mul_f32 v[16:17], v[16:17], v[24:25] op_sel_hi:[1,0]
    v_mfma_f32_16x16x32_bf16 v[68:71], v[172:175], a[124:127], v[68:71]
    ds_read_b128 v[160:163], v9 offset:10240
    v_pk_mul_f32 v[18:19], v[18:19], v[24:25] op_sel_hi:[1,0]
    v_pk_mul_f32 v[20:21], v[20:21], v[24:25] op_sel_hi:[1,0]
    buffer_load_dwordx4 a[168:171], v2, s[20:23], s30 offen offset:2048 sc1
    s_waitcnt vmcnt(10) lgkmcnt(6)
    v_mfma_f32_16x16x32_bf16 v[72:75], v[128:131], a[128:131], 0
    ds_read_b128 v[164:167], v8 offset:11264
    v_pk_mul_f32 v[22:23], v[22:23], v[24:25] op_sel_hi:[1,0]
    v_mfma_f32_16x16x32_bf16 v[76:79], v[132:135], a[128:131], 0
    ds_read_b128 v[168:171], v8 offset:44032
    v_mfma_f32_16x16x32_bf16 v[80:83], v[136:139], a[128:131], 0
    ds_read_b128 v[172:175], v9 offset:11264
    buffer_load_dwordx4 a[172:175], v2, s[20:23], s30 offen offset:3072 sc1
    s_waitcnt vmcnt(10) lgkmcnt(6)
    v_mfma_f32_16x16x32_bf16 v[72:75], v[140:143], a[132:135], v[72:75]
    ds_read_b128 v[128:131], v8 offset:12288
    v_mfma_f32_16x16x32_bf16 v[76:79], v[144:147], a[132:135], v[76:79]
    ds_read_b128 v[132:135], v8 offset:45056
    v_mfma_f32_16x16x32_bf16 v[80:83], v[148:151], a[132:135], v[80:83]
    ds_read_b128 v[136:139], v9 offset:12288
    s_add_u32 s30, s93, 20480
    buffer_load_dwordx4 a[176:179], v2, s[20:23], s30 offen offset:0 sc1
    s_waitcnt vmcnt(10) lgkmcnt(6)
    v_mfma_f32_16x16x32_bf16 v[72:75], v[152:155], a[136:139], v[72:75]
    ds_read_b128 v[140:143], v8 offset:13312
    v_mfma_f32_16x16x32_bf16 v[76:79], v[156:159], a[136:139], v[76:79]
    ds_read_b128 v[144:147], v8 offset:46080
    v_mfma_f32_16x16x32_bf16 v[80:83], v[160:163], a[136:139], v[80:83]
    ds_read_b128 v[148:151], v9 offset:13312
    buffer_load_dwordx4 a[180:183], v2, s[20:23], s30 offen offset:1024 sc1
    s_waitcnt vmcnt(10) lgkmcnt(6)
    v_mfma_f32_16x16x32_bf16 v[72:75], v[164:167], a[140:143], v[72:75]
    ds_read_b128 v[152:155], v8 offset:14336
    v_mfma_f32_16x16x32_bf16 v[76:79], v[168:171], a[140:143], v[76:79]
    ds_read_b128 v[156:159], v8 offset:47104
    v_mfma_f32_16x16x32_bf16 v[80:83], v[172:175], a[140:143], v[80:83]
    ds_read_b128 v[160:163], v9 offset:14336
    buffer_load_dwordx4 a[184:187], v2, s[20:23], s30 offen offset:2048 sc1
    s_waitcnt vmcnt(10) lgkmcnt(6)
    v_mfma_f32_16x16x32_bf16 v[84:87], v[128:131], a[144:147], 0
    ds_read_b128 v[164:167], v8 offset:15360
    v_mfma_f32_16x16x32_bf16 v[88:91], v[132:135], a[144:147], 0
    ds_read_b128 v[168:171], v8 offset:48128
    v_mfma_f32_16x16x32_bf16 v[92:95], v[136:139], a[144:147], 0
    ds_read_b128 v[172:175], v9 offset:15360
    buffer_load_dwordx4 a[188:191], v2, s[20:23], s30 offen offset:3072 sc1
    s_waitcnt vmcnt(10) lgkmcnt(6)
    v_mfma_f32_16x16x32_bf16 v[84:87], v[140:143], a[148:151], v[84:87]
    ds_read_b128 v[128:131], v8 offset:16384
    v_pk_mul_f32 v[32:33], v[48:49], v[16:17] op_sel:[0,0] op_sel_hi:[1,0]
    v_pk_mul_f32 v[34:35], v[50:51], v[16:17] op_sel:[0,0] op_sel_hi:[1,0]
    v_mfma_f32_16x16x32_bf16 v[88:91], v[144:147], a[148:151], v[88:91]
    ds_read_b128 v[132:135], v8 offset:49152
    v_pk_mul_f32 v[36:37], v[52:53], v[16:17] op_sel:[0,0] op_sel_hi:[1,0]
    v_pk_mul_f32 v[38:39], v[54:55], v[16:17] op_sel:[0,0] op_sel_hi:[1,0]
    v_mfma_f32_16x16x32_bf16 v[92:95], v[148:151], a[148:151], v[92:95]
    ds_read_b128 v[136:139], v9 offset:16384
    v_pk_mul_f32 v[40:41], v[56:57], v[16:17] op_sel:[0,0] op_sel_hi:[1,0]
    v_pk_mul_f32 v[42:43], v[58:59], v[16:17] op_sel:[0,0] op_sel_hi:[1,0]
    s_add_u32 s30, s93, 24576
    buffer_load_dwordx4 a[192:195], v2, s[20:23], s30 offen offset:0 sc1
    s_waitcnt vmcnt(10) lgkmcnt(6)
    v_mfma_f32_16x16x32_bf16 v[84:87], v[152:155], a[152:155], v[84:87]
    ds_read_b128 v[140:143], v8 offset:17408
    v_mfma_f32_16x16x32_bf16 v[88:91], v[156:159], a[152:155], v[88:91]
    ds_read_b128 v[144:147], v8 offset:50176
    v_mfma_f32_16x16x32_bf16 v[92:95], v[160:163], a[152:155], v[92:95]
    ds_read_b128 v[148:151], v9 offset:17408
    buffer_load_dwordx4 a[196:199], v2, s[20:23], s30 offen offset:1024 sc1
    s_waitcnt vmcnt(10) lgkmcnt(6)
    v_mfma_f32_16x16x32_bf16 v[84:87], v[164:167], a[156:159], v[84:87]
    ds_read_b128 v[152:155], v8 offset:18432
    v_mfma_f32_16x16x32_bf16 v[88:91], v[168:171], a[156:159], v[88:91]
    ds_read_b128 v[156:159], v8 offset:51200
    v_mfma_f32_16x16x32_bf16 v[92:95], v[172:175], a[156:159], v[92:95]
    ds_read_b128 v[160:163], v9 offset:18432
    buffer_load_dwordx4 a[200:203], v2, s[20:23], s30 offen offset:2048 sc1
    s_waitcnt vmcnt(10) lgkmcnt(6)
    v_mfma_f32_16x16x32_bf16 v[48:51], v[128:131], a[160:163], 0
    ds_read_b128 v[164:167], v8 offset:19456
    v_mfma_f32_16x16x32_bf16 v[52:55], v[132:135], a[160:163], 0
    ds_read_b128 v[168:171], v8 offset:52224
    v_mfma_f32_16x16x32_bf16 v[56:59], v[136:139], a[160:163], 0
    ds_read_b128 v[172:175], v9 offset:19456
    buffer_load_dwordx4 a[204:207], v2, s[20:23], s30 offen offset:3072 sc1
    s_waitcnt vmcnt(10) lgkmcnt(6)
    v_mfma_f32_16x16x32_bf16 v[48:51], v[140:143], a[164:167], v[48:51]
    ds_read_b128 v[128:131], v8 offset:20480
    v_pk_fma_f32 v[32:33], v[60:61], v[16:17], v[32:33] op_sel:[0,1,0] op_sel_hi:[1,1,1]
    v_pk_fma_f32 v[34:35], v[62:63], v[16:17], v[34:35] op_sel:[0,1,0] op_sel_hi:[1,1,1]
    v_mfma_f32_16x16x32_bf16 v[52:55], v[144:147], a[164:167], v[52:55]
    ds_read_b128 v[132:135], v8 offset:53248
    v_pk_fma_f32 v[36:37], v[64:65], v[16:17], v[36:37] op_sel:[0,1,0] op_sel_hi:[1,1,1]
    v_pk_fma_f32 v[38:39], v[66:67], v[16:17], v[38:39] op_sel:[0,1,0] op_sel_hi:[1,1,1]
    v_mfma_f32_16x16x32_bf16 v[56:59], v[148:151], a[164:167], v[56:59]
    ds_read_b128 v[136:139], v9 offset:20480
    v_pk_fma_f32 v[40:41], v[68:69], v[16:17], v[40:41] op_sel:[0,1,0] op_sel_hi:[1,1,1]
    v_pk_fma_f32 v[42:43], v[70:71], v[16:17], v[42:43] op_sel:[0,1,0] op_sel_hi:[1,1,1]
    s_add_u32 s30, s93, 28672
    buffer_load_dwordx4 a[208:211], v2, s[20:23], s30 offen offset:0 sc1
    s_waitcnt vmcnt(10) lgkmcnt(6)
    v_mfma_f32_16x16x32_bf16 v[48:51], v[152:155], a[168:171], v[48:51]
    ds_read_b128 v[140:143], v8 offset:21504
    v_mfma_f32_16x16x32_bf16 v[52:55], v[156:159], a[168:171], v[52:55]
    ds_read_b128 v[144:147], v8 offset:54272
    v_mfma_f32_16x16x32_bf16 v[56:59], v[160:163], a[168:171], v[56:59]
    ds_read_b128 v[148:151], v9 offset:21504
    buffer_load_dwordx4 a[212:215], v2, s[20:23], s30 offen offset:1024 sc1
    s_waitcnt vmcnt(10) lgkmcnt(6)
    v_mfma_f32_16x16x32_bf16 v[48:51], v[164:167], a[172:175], v[48:51]
    ds_read_b128 v[152:155], v8 offset:22528
    v_mfma_f32_16x16x32_bf16 v[52:55], v[168:171], a[172:175], v[52:55]
    ds_read_b128 v[156:159], v8 offset:55296
    v_mfma_f32_16x16x32_bf16 v[56:59], v[172:175], a[172:175], v[56:59]
    ds_read_b128 v[160:163], v9 offset:22528
    buffer_load_dwordx4 a[216:219], v2, s[20:23], s30 offen offset:2048 sc1
    s_waitcnt vmcnt(10) lgkmcnt(6)
    v_mfma_f32_16x16x32_bf16 v[60:63], v[128:131], a[176:179], 0
    ds_read_b128 v[164:167], v8 offset:23552
    v_mfma_f32_16x16x32_bf16 v[64:67], v[132:135], a[176:179], 0
    ds_read_b128 v[168:171], v8 offset:56320
    v_mfma_f32_16x16x32_bf16 v[68:71], v[136:139], a[176:179], 0
    ds_read_b128 v[172:175], v9 offset:23552
    buffer_load_dwordx4 a[220:223], v2, s[20:23], s30 offen offset:3072 sc1
    s_waitcnt vmcnt(10) lgkmcnt(6)
    v_mfma_f32_16x16x32_bf16 v[60:63], v[140:143], a[180:183], v[60:63]
    ds_read_b128 v[128:131], v8 offset:24576
    v_pk_fma_f32 v[32:33], v[72:73], v[18:19], v[32:33] op_sel:[0,0,0] op_sel_hi:[1,0,1]
    v_pk_fma_f32 v[34:35], v[74:75], v[18:19], v[34:35] op_sel:[0,0,0] op_sel_hi:[1,0,1]
    v_mfma_f32_16x16x32_bf16 v[64:67], v[144:147], a[180:183], v[64:67]
    ds_read_b128 v[132:135], v8 offset:57344
    v_pk_fma_f32 v[36:37], v[76:77], v[18:19], v[36:37] op_sel:[0,0,0] op_sel_hi:[1,0,1]
    v_pk_fma_f32 v[38:39], v[78:79], v[18:19], v[38:39] op_sel:[0,0,0] op_sel_hi:[1,0,1]
    v_mfma_f32_16x16x32_bf16 v[68:71], v[148:151], a[180:183], v[68:71]
    ds_read_b128 v[136:139], v9 offset:24576
    v_pk_fma_f32 v[40:41], v[80:81], v[18:19], v[40:41] op_sel:[0,0,0] op_sel_hi:[1,0,1]
    v_pk_fma_f32 v[42:43], v[82:83], v[18:19], v[42:43] op_sel:[0,0,0] op_sel_hi:[1,0,1]
    s_waitcnt vmcnt(9) lgkmcnt(6)
    v_mfma_f32_16x16x32_bf16 v[60:63], v[152:155], a[184:187], v[60:63]
    ds_read_b128 v[140:143], v8 offset:25600
    v_mfma_f32_16x16x32_bf16 v[64:67], v[156:159], a[184:187], v[64:67]
    ds_read_b128 v[144:147], v8 offset:58368
    v_mfma_f32_16x16x32_bf16 v[68:71], v[160:163], a[184:187], v[68:71]
    ds_read_b128 v[148:151], v9 offset:25600
    s_waitcnt vmcnt(8) lgkmcnt(6)
    v_mfma_f32_16x16x32_bf16 v[60:63], v[164:167], a[188:191], v[60:63]
    ds_read_b128 v[152:155], v8 offset:26624
    v_mfma_f32_16x16x32_bf16 v[64:67], v[168:171], a[188:191], v[64:67]
    ds_read_b128 v[156:159], v8 offset:59392
    v_mfma_f32_16x16x32_bf16 v[68:71], v[172:175], a[188:191], v[68:71]
    ds_read_b128 v[160:163], v9 offset:26624
    s_waitcnt vmcnt(7) lgkmcnt(6)
    v_mfma_f32_16x16x32_bf16 v[72:75], v[128:131], a[192:195], 0
    ds_read_b128 v[164:167], v8 offset:27648
    v_mfma_f32_16x16x32_bf16 v[76:79], v[132:135], a[192:195], 0
    ds_read_b128 v[168:171], v8 offset:60416
    v_mfma_f32_16x16x32_bf16 v[80:83], v[136:139], a[192:195], 0
    ds_read_b128 v[172:175], v9 offset:27648
    s_waitcnt vmcnt(6) lgkmcnt(6)
    v_mfma_f32_16x16x32_bf16 v[72:75], v[140:143], a[196:199], v[72:75]
    ds_read_b128 v[128:131], v8 offset:28672
    v_pk_fma_f32 v[32:33], v[84:85], v[18:19], v[32:33] op_sel:[0,1,0] op_sel_hi:[1,1,1]
    v_pk_fma_f32 v[34:35], v[86:87], v[18:19], v[34:35] op_sel:[0,1,0] op_sel_hi:[1,1,1]
    v_mfma_f32_16x16x32_bf16 v[76:79], v[144:147], a[196:199], v[76:79]
    ds_read_b128 v[132:135], v8 offset:61440
    v_pk_fma_f32 v[36:37], v[88:89], v[18:19], v[36:37] op_sel:[0,1,0] op_sel_hi:[1,1,1]
    v_pk_fma_f32 v[38:39], v[90:91], v[18:19], v[38:39] op_sel:[0,1,0] op_sel_hi:[1,1,1]
    v_mfma_f32_16x16x32_bf16 v[80:83], v[148:151], a[196:199], v[80:83]
    ds_read_b128 v[136:139], v9 offset:28672
    v_pk_fma_f32 v[40:41], v[92:93], v[18:19], v[40:41] op_sel:[0,1,0] op_sel_hi:[1,1,1]
    v_pk_fma_f32 v[42:43], v[94:95], v[18:19], v[42:43] op_sel:[0,1,0] op_sel_hi:[1,1,1]
    s_waitcnt vmcnt(5) lgkmcnt(6)
    v_mfma_f32_16x16x32_bf16 v[72:75], v[152:155], a[200:203], v[72:75]
    ds_read_b128 v[140:143], v8 offset:29696
    v_mfma_f32_16x16x32_bf16 v[76:79], v[156:159], a[200:203], v[76:79]
    ds_read_b128 v[144:147], v8 offset:62464
    v_mfma_f32_16x16x32_bf16 v[80:83], v[160:163], a[200:203], v[80:83]
    ds_read_b128 v[148:151], v9 offset:29696
    s_waitcnt vmcnt(4) lgkmcnt(6)
    v_mfma_f32_16x16x32_bf16 v[72:75], v[164:167], a[204:207], v[72:75]
    ds_read_b128 v[152:155], v8 offset:30720
    v_mfma_f32_16x16x32_bf16 v[76:79], v[168:171], a[204:207], v[76:79]
    ds_read_b128 v[156:159], v8 offset:63488
    v_mfma_f32_16x16x32_bf16 v[80:83], v[172:175], a[204:207], v[80:83]
    ds_read_b128 v[160:163], v9 offset:30720
    s_waitcnt vmcnt(3) lgkmcnt(6)
    v_mfma_f32_16x16x32_bf16 v[84:87], v[128:131], a[208:211], 0
    ds_read_b128 v[164:167], v8 offset:31744
    v_mfma_f32_16x16x32_bf16 v[88:91], v[132:135], a[208:211], 0
    ds_read_b128 v[168:171], v8 offset:64512
    v_mfma_f32_16x16x32_bf16 v[92:95], v[136:139], a[208:211], 0
    ds_read_b128 v[172:175], v9 offset:31744
    s_waitcnt vmcnt(2) lgkmcnt(6)
    v_mfma_f32_16x16x32_bf16 v[84:87], v[140:143], a[212:215], v[84:87]
    v_pk_fma_f32 v[32:33], v[48:49], v[20:21], v[32:33] op_sel:[0,0,0] op_sel_hi:[1,0,1]
    v_pk_fma_f32 v[34:35], v[50:51], v[20:21], v[34:35] op_sel:[0,0,0] op_sel_hi:[1,0,1]
    v_mfma_f32_16x16x32_bf16 v[88:91], v[144:147], a[212:215], v[88:91]
    v_pk_fma_f32 v[36:37], v[52:53], v[20:21], v[36:37] op_sel:[0,0,0] op_sel_hi:[1,0,1]
    v_pk_fma_f32 v[38:39], v[54:55], v[20:21], v[38:39] op_sel:[0,0,0] op_sel_hi:[1,0,1]
    v_mfma_f32_16x16x32_bf16 v[92:95], v[148:151], a[212:215], v[92:95]
    v_pk_fma_f32 v[40:41], v[56:57], v[20:21], v[40:41] op_sel:[0,0,0] op_sel_hi:[1,0,1]
    v_pk_fma_f32 v[42:43], v[58:59], v[20:21], v[42:43] op_sel:[0,0,0] op_sel_hi:[1,0,1]
    s_waitcnt vmcnt(1) lgkmcnt(3)
    v_mfma_f32_16x16x32_bf16 v[84:87], v[152:155], a[216:219], v[84:87]
    v_mfma_f32_16x16x32_bf16 v[88:91], v[156:159], a[216:219], v[88:91]
    v_mfma_f32_16x16x32_bf16 v[92:95], v[160:163], a[216:219], v[92:95]
    s_waitcnt vmcnt(0) lgkmcnt(0)
    v_mfma_f32_16x16x32_bf16 v[84:87], v[164:167], a[220:223], v[84:87]
    v_mfma_f32_16x16x32_bf16 v[88:91], v[168:171], a[220:223], v[88:91]
    v_mfma_f32_16x16x32_bf16 v[92:95], v[172:175], a[220:223], v[92:95]
    v_pk_fma_f32 v[32:33], v[60:61], v[20:21], v[32:33] op_sel:[0,1,0] op_sel_hi:[1,1,1]
    v_pk_fma_f32 v[34:35], v[62:63], v[20:21], v[34:35] op_sel:[0,1,0] op_sel_hi:[1,1,1]
    v_pk_fma_f32 v[36:37], v[64:65], v[20:21], v[36:37] op_sel:[0,1,0] op_sel_hi:[1,1,1]
    v_pk_fma_f32 v[38:39], v[66:67], v[20:21], v[38:39] op_sel:[0,1,0] op_sel_hi:[1,1,1]
    v_pk_fma_f32 v[40:41], v[68:69], v[20:21], v[40:41] op_sel:[0,1,0] op_sel_hi:[1,1,1]
    v_pk_fma_f32 v[42:43], v[70:71], v[20:21], v[42:43] op_sel:[0,1,0] op_sel_hi:[1,1,1]
    v_pk_fma_f32 v[32:33], v[72:73], v[22:23], v[32:33] op_sel:[0,0,0] op_sel_hi:[1,0,1]
    v_pk_fma_f32 v[34:35], v[74:75], v[22:23], v[34:35] op_sel:[0,0,0] op_sel_hi:[1,0,1]
    v_pk_fma_f32 v[36:37], v[76:77], v[22:23], v[36:37] op_sel:[0,0,0] op_sel_hi:[1,0,1]
    v_pk_fma_f32 v[38:39], v[78:79], v[22:23], v[38:39] op_sel:[0,0,0] op_sel_hi:[1,0,1]
    v_pk_fma_f32 v[40:41], v[80:81], v[22:23], v[40:41] op_sel:[0,0,0] op_sel_hi:[1,0,1]
    v_pk_fma_f32 v[42:43], v[82:83], v[22:23], v[42:43] op_sel:[0,0,0] op_sel_hi:[1,0,1]
    v_pk_fma_f32 v[32:33], v[84:85], v[22:23], v[32:33] op_sel:[0,1,0] op_sel_hi:[1,1,1]
    v_pk_fma_f32 v[34:35], v[86:87], v[22:23], v[34:35] op_sel:[0,1,0] op_sel_hi:[1,1,1]
    v_pk_fma_f32 v[36:37], v[88:89], v[22:23], v[36:37] op_sel:[0,1,0] op_sel_hi:[1,1,1]
    v_pk_fma_f32 v[38:39], v[90:91], v[22:23], v[38:39] op_sel:[0,1,0] op_sel_hi:[1,1,1]
    v_pk_fma_f32 v[40:41], v[92:93], v[22:23], v[40:41] op_sel:[0,1,0] op_sel_hi:[1,1,1]
    v_pk_fma_f32 v[42:43], v[94:95], v[22:23], v[42:43] op_sel:[0,1,0] op_sel_hi:[1,1,1]
    s_branch LN_pv_check
    .fill 64, 4, 0xbf800000
LN_codeend:
    s_endpgm
.section .rodata,"a"
.p2align 6
.amdhsa_kernel prep_kernel
  .amdhsa_next_free_vgpr 120
  .amdhsa_next_free_sgpr 102
  .amdhsa_accum_offset 120
  .amdhsa_group_segment_fixed_size 0
  .amdhsa_kernarg_size 64
  .amdhsa_user_sgpr_count 2
  .amdhsa_user_sgpr_kernarg_segment_ptr 1
  .amdhsa_system_sgpr_workgroup_id_x 1
.end_amdhsa_kernel
.p2align 6
.amdhsa_kernel main_kernel
  .amdhsa_next_free_vgpr 480
  .amdhsa_next_free_sgpr 102
  .amdhsa_accum_offset 256
  .amdhsa_group_segment_fixed_size 0
  .amdhsa_kernarg_size 64
  .amdhsa_user_sgpr_count 2
  .amdhsa_user_sgpr_kernarg_segment_ptr 1
  .amdhsa_system_sgpr_workgroup_id_x 1
.end_amdhsa_kernel
```
